```python
import torch

def _softmax(x, axis=-1):
    return torch.softmax(x, dim=axis)
def _gelu(x):
    return torch.nn.functional.gelu(x, approximate="tanh")
def _silu(x):
    return torch.nn.functional.silu(x)
def _sigmoid(x):
    return torch.sigmoid(x)
def _layernorm(x, axis=-1, eps=1e-5):
    m = x.mean(dim=axis, keepdim=True)
    v = x.var(dim=axis, keepdim=True, unbiased=False)
    return (x - m) / torch.sqrt(v + eps)
def _scatter_add(tgt, idx, src, axis=0):
    return tgt.clone().index_add_(axis, idx, src)
def _segment_sum(src, seg, n):
    out = torch.zeros((n,) + src.shape[1:], dtype=src.dtype)
    return out.index_add_(0, seg, src)
def _pad(x, pw):
    flat = tuple(v for pair in reversed(pw) for v in pair)
    return torch.nn.functional.pad(x, flat)

kernel_name = 'recurrent_scan__sliding_block_cached__geglu_ffn__prompt'

def setup_inputs():

    _w = (lambda a: (lambda t: t.to(torch.bfloat16) if t.is_floating_point() else t)(torch.as_tensor(a)))
    def _A_setup():
        B, Sq, D = 1, 2048, 512
        Hq, Hkv, Sk, Dh = 32, 32, 2048, 128
        assert Hq % Hkv == 0, (Hq, Hkv)
        return {
            "x": _w((lambda *s: torch.randn(*s, dtype=torch.bfloat16) * 0.05)(B, Sq, D)),
            "k_cache": _w((lambda *s: torch.randn(*s, dtype=torch.bfloat16) * 0.8)(B, Hkv, Sk, Dh)),
            "v_cache": _w((lambda *s: torch.randn(*s, dtype=torch.bfloat16) * 0.2)(B, Hkv, Sk, Dh)),
            "wq": _w((lambda *s: torch.randn(*s, dtype=torch.bfloat16) * 0.8)(D, Hq * Dh) * (D ** -0.5)),
            "wo": _w((lambda *s: torch.randn(*s, dtype=torch.bfloat16) * 0.2)(Hq * Dh, D) * ((Hq * Dh) ** -0.5)),
        }
    _A_in = _A_setup()

    def _B_setup():
        B, S, D, F = 1, 2048, 512, 1376
        return {
            "x": _w((lambda *s: torch.randn(*s, dtype=torch.bfloat16) * 0.05)(B, S, D)),
            "w_gate": _w((lambda *s: torch.randn(*s, dtype=torch.bfloat16) * 0.1)(D, F)),
            "w_up": _w((lambda *s: torch.randn(*s, dtype=torch.bfloat16) * 0.1)(D, F)),
            "w_down": _w((lambda *s: torch.randn(*s, dtype=torch.bfloat16) * 0.1)(F, D)),
        }
    _B_in = _B_setup()

    return {
        "A_x": _A_in["x"],
        "A_k_cache": _A_in["k_cache"],
        "A_v_cache": _A_in["v_cache"],
        "A_wq": _A_in["wq"],
        "A_wo": _A_in["wo"],
        "B_x": _B_in["x"],
        "B_w_gate": _B_in["w_gate"],
        "B_w_up": _B_in["w_up"],
        "B_w_down": _B_in["w_down"],
    }

def reference(A_x, A_k_cache, A_v_cache, A_wq, A_wo, B_x, B_w_gate, B_w_up, B_w_down):
    def _A_ref(x, k_cache, v_cache, wq, wo):
        B, Sq, D = x.shape
        Hq, Dh = 32, 128
        Hkv, Sk = k_cache.shape[1], k_cache.shape[2]
        W = min(4096, max(256, Sk // 4))
        rep = Hq // Hkv
        q = (lambda x, *d: x.permute(*d))((x @ wq).reshape(B, Sq, Hq, Dh), 0, 2, 1, 3)
        k = (lambda x, n, axis: torch.repeat_interleave(x, n, dim=axis))(k_cache[:, :, Sk - W:, :], rep, axis=1)
        v = (lambda x, n, axis: torch.repeat_interleave(x, n, dim=axis))(v_cache[:, :, Sk - W:, :], rep, axis=1)
        scores = torch.einsum("bhqd,bhkd->bhqk", q, k) * (Dh ** -0.5)
        p = _softmax(scores, axis=-1)
        o = torch.einsum("bhqk,bhkd->bhqd", p, v)
        return (lambda x, *d: x.permute(*d))(o, 0, 2, 1, 3).reshape(B, Sq, Hq * Dh) @ wo

    def _B_ref(x, w_gate, w_up, w_down):
        return (_gelu(x @ w_gate) * (x @ w_up)) @ w_down

    x = A_x
    xn = _layernorm(x, axis=-1)
    s = _A_ref(xn, A_k_cache, A_v_cache, A_wq, A_wo)
    g = _silu(_B_ref(xn, B_w_gate, B_w_up, B_w_down))
    return x + s * g
```

```asm
; @launch kernel=ln_kernel grid=(512,1,1) block=(256,1,1) lds=0
; @launch kernel=attn_kernel grid=(256,1,1) block=(512,1,1) lds=163840
; @launch kernel=gemm2_kernel grid=(256,1,1) block=(512,1,1) lds=163840
; @launch kernel=fin_kernel grid=(512,1,1) block=(256,1,1) lds=0
.amdgcn_target "amdgcn-amd-amdhsa--gfx950"
.text
.globl ln_kernel
.p2align 8
.type ln_kernel,@function
ln_kernel:
    s_cmp_ge_u32 s2, 512
    s_cbranch_scc1 L_ln_end
    s_load_dwordx2 s[4:5], s[0:1], 0
    s_load_dwordx2 s[6:7], s[0:1], 88
    v_lshlrev_b32 v1, 4, v0
    s_lshl_b32 s3, s2, 12
    s_waitcnt lgkmcnt(0)
    s_mov_b32 s8, s4
    s_and_b32 s9, s5, 65535
    s_mov_b32 s10, 2097152
    s_mov_b32 s11, 131072
    s_mov_b32 s12, s6
    s_and_b32 s13, s7, 65535
    s_mov_b32 s14, 2097152
    s_mov_b32 s15, 131072
    buffer_load_dwordx4 v[44:47], v1, s[8:11], s3 offen
    s_load_dwordx2 s[24:25], s[0:1], 24
    s_load_dwordx4 s[28:31], s[0:1], 48
    v_lshrrev_b32 v2, 6, v0
    s_nop 0
    v_readfirstlane_b32 s18, v2
    v_and_b32 v2, 63, v0
    s_and_b32 s19, s2, 7
    s_lshl_b32 s19, s19, 2
    s_nop 0
    s_add_u32 s19, s19, s18
    s_lshr_b32 s26, s2, 3
    s_waitcnt lgkmcnt(0)
    s_mov_b32 s40, s24
    s_and_b32 s41, s25, 65535
    s_mov_b32 s42, 4194304
    s_mov_b32 s43, 131072
    s_mov_b32 s44, s28
    s_and_b32 s45, s29, 65535
    s_mov_b32 s46, 1409024
    s_mov_b32 s47, 131072
    s_mov_b32 s48, s30
    s_and_b32 s49, s31, 65535
    s_mov_b32 s50, 1409024
    s_mov_b32 s51, 131072
    v_lshrrev_b32 v5, 4, v2
    v_and_b32 v6, 15, v2
    v_lshlrev_b32 v6, 4, v6
    v_lshl_add_u32 v5, v5, 13, v6
    v_min_u32 v6, 47, v2
    v_mul_u32_u24 v7, 43, v6
    v_lshrrev_b32 v7, 8, v7
    v_mul_u32_u24 v8, 6, v7
    v_sub_u32 v8, v6, v8
    v_mul_u32_u24 v7, 2752, v7
    v_lshrrev_b32 v9, 1, v8
    v_lshl_add_u32 v7, v9, 10, v7
    v_and_b32 v8, 1, v8
    v_lshl_add_u32 v7, v8, 4, v7
    s_lshl_b32 s27, s26, 16
    s_lshl_b32 s52, s19, 8
    s_add_u32 s27, s27, s52
    buffer_load_dwordx4 v[28:31], v5, s[40:43], s27 offen
    s_add_u32 s27, s27, 32768
    buffer_load_dwordx4 v[32:35], v5, s[40:43], s27 offen
    s_mul_i32 s27, s26, 22016
    s_lshl_b32 s52, s19, 5
    s_add_u32 s27, s27, s52
    buffer_load_dwordx4 v[36:39], v7, s[44:47], s27 offen
    buffer_load_dwordx4 v[40:43], v7, s[48:51], s27 offen
    s_waitcnt vmcnt(4)
    v_mov_b32 v4, v44
    v_mov_b32 v5, v45
    v_mov_b32 v6, v46
    v_mov_b32 v7, v47
    v_lshlrev_b32 v8, 16, v4
    v_and_b32 v9, 4294901760, v4
    v_lshlrev_b32 v10, 16, v5
    v_and_b32 v11, 4294901760, v5
    v_lshlrev_b32 v12, 16, v6
    v_and_b32 v13, 4294901760, v6
    v_lshlrev_b32 v14, 16, v7
    v_and_b32 v15, 4294901760, v7
    v_add_f32 v16, v8, v9
    v_add_f32 v16, v16, v10
    v_add_f32 v16, v16, v11
    v_add_f32 v16, v16, v12
    v_add_f32 v16, v16, v13
    v_add_f32 v16, v16, v14
    v_add_f32 v16, v16, v15
    ds_swizzle_b32 v17, v16 offset:0x041f
    s_waitcnt lgkmcnt(0)
    v_add_f32 v16, v16, v17
    ds_swizzle_b32 v17, v16 offset:0x081f
    s_waitcnt lgkmcnt(0)
    v_add_f32 v16, v16, v17
    ds_swizzle_b32 v17, v16 offset:0x101f
    s_waitcnt lgkmcnt(0)
    v_add_f32 v16, v16, v17
    ds_swizzle_b32 v17, v16 offset:0x201f
    s_waitcnt lgkmcnt(0)
    v_add_f32 v16, v16, v17
    ds_swizzle_b32 v17, v16 offset:0x401f
    s_waitcnt lgkmcnt(0)
    v_add_f32 v16, v16, v17
    v_mov_b32 v17, v16
    s_nop 1
    v_permlane32_swap_b32 v16, v17
    v_add_f32 v16, v16, v17
    v_mul_f32 v16, 0x3b000000, v16
    v_sub_f32 v18, v8, v16
    v_mul_f32 v19, v18, v18
    v_sub_f32 v18, v9, v16
    v_fmac_f32 v19, v18, v18
    v_sub_f32 v18, v10, v16
    v_fmac_f32 v19, v18, v18
    v_sub_f32 v18, v11, v16
    v_fmac_f32 v19, v18, v18
    v_sub_f32 v18, v12, v16
    v_fmac_f32 v19, v18, v18
    v_sub_f32 v18, v13, v16
    v_fmac_f32 v19, v18, v18
    v_sub_f32 v18, v14, v16
    v_fmac_f32 v19, v18, v18
    v_sub_f32 v18, v15, v16
    v_fmac_f32 v19, v18, v18
    ds_swizzle_b32 v17, v19 offset:0x041f
    s_waitcnt lgkmcnt(0)
    v_add_f32 v19, v19, v17
    ds_swizzle_b32 v17, v19 offset:0x081f
    s_waitcnt lgkmcnt(0)
    v_add_f32 v19, v19, v17
    ds_swizzle_b32 v17, v19 offset:0x101f
    s_waitcnt lgkmcnt(0)
    v_add_f32 v19, v19, v17
    ds_swizzle_b32 v17, v19 offset:0x201f
    s_waitcnt lgkmcnt(0)
    v_add_f32 v19, v19, v17
    ds_swizzle_b32 v17, v19 offset:0x401f
    s_waitcnt lgkmcnt(0)
    v_add_f32 v19, v19, v17
    v_mov_b32 v17, v19
    s_nop 1
    v_permlane32_swap_b32 v19, v17
    v_add_f32 v19, v19, v17
    v_mul_f32 v19, 0x3b000000, v19
    v_cvt_pk_bf16_f32 v20, v16, v19
    v_lshlrev_b32 v16, 16, v20
    v_and_b32 v19, 4294901760, v20
    v_add_f32 v19, 0x3727c5ac, v19
    v_cvt_pk_bf16_f32 v20, v19, v19
    v_lshlrev_b32 v19, 16, v20
    v_sqrt_f32 v19, v19
    s_nop 0
    v_cvt_pk_bf16_f32 v20, v19, v19
    v_lshlrev_b32 v19, 16, v20
    v_rcp_f32 v19, v19
    v_sub_f32 v20, v8, v16
    v_sub_f32 v21, v9, v16
    v_cvt_pk_bf16_f32 v22, v20, v21
    v_lshlrev_b32 v20, 16, v22
    v_and_b32 v21, 4294901760, v22
    v_mul_f32 v20, v20, v19
    v_mul_f32 v21, v21, v19
    v_cvt_pk_bf16_f32 v24, v20, v21
    v_sub_f32 v20, v10, v16
    v_sub_f32 v21, v11, v16
    v_cvt_pk_bf16_f32 v22, v20, v21
    v_lshlrev_b32 v20, 16, v22
    v_and_b32 v21, 4294901760, v22
    v_mul_f32 v20, v20, v19
    v_mul_f32 v21, v21, v19
    v_cvt_pk_bf16_f32 v25, v20, v21
    v_sub_f32 v20, v12, v16
    v_sub_f32 v21, v13, v16
    v_cvt_pk_bf16_f32 v22, v20, v21
    v_lshlrev_b32 v20, 16, v22
    v_and_b32 v21, 4294901760, v22
    v_mul_f32 v20, v20, v19
    v_mul_f32 v21, v21, v19
    v_cvt_pk_bf16_f32 v26, v20, v21
    v_sub_f32 v20, v14, v16
    v_sub_f32 v21, v15, v16
    v_cvt_pk_bf16_f32 v22, v20, v21
    v_lshlrev_b32 v20, 16, v22
    v_and_b32 v21, 4294901760, v22
    v_mul_f32 v20, v20, v19
    v_mul_f32 v21, v21, v19
    v_cvt_pk_bf16_f32 v27, v20, v21
    v_and_b32 v2, 63, v0
    v_lshrrev_b32 v3, 1, v2
    v_lshlrev_b32 v3, 10, v3
    v_and_b32 v2, 1, v2
    v_lshl_add_u32 v3, v2, 9, v3
    v_lshrrev_b32 v2, 6, v0
    v_lshl_add_u32 v3, v2, 4, v3
    s_lshr_b32 s16, s2, 3
    s_lshl_b32 s16, s16, 15
    s_and_b32 s17, s2, 7
    s_lshl_b32 s17, s17, 6
    s_add_u32 s16, s16, s17
    buffer_store_dwordx4 v[24:27], v3, s[12:15], s16 offen
    s_cmp_lg_u32 s2, 0
    s_cbranch_scc1 L_ln_end
    s_add_u32 s8, s6, 24903680
    s_addc_u32 s9, s7, 0
    s_and_b32 s9, s9, 65535
    s_mov_b32 s10, 256
    s_mov_b32 s11, 131072
    v_lshlrev_b32 v2, 2, v0
    v_mov_b32 v3, 0
    buffer_store_dword v3, v2, s[8:11], 0 offen
L_ln_end:
    s_endpgm
.globl attn_kernel
.p2align 8
.type attn_kernel,@function
attn_kernel:
    s_cmp_ge_u32 s2, 256
    s_cbranch_scc1 L_at_end
    s_load_dwordx4 s[4:7], s[0:1], 8
    s_load_dwordx2 s[8:9], s[0:1], 24
    s_load_dwordx4 s[12:15], s[0:1], 48
    s_load_dwordx2 s[10:11], s[0:1], 88
    s_load_dwordx2 s[96:97], s[0:1], 32
    s_load_dwordx2 s[98:99], s[0:1], 64
    v_lshrrev_b32 v7, 6, v0
    v_and_b32 v1, 63, v0
    v_readfirstlane_b32 s48, v7
    s_and_b32 s49, s2, 7
    s_lshl_b32 s49, s49, 2
    s_lshr_b32 s51, s2, 3
    s_and_b32 s51, s51, 3
    s_add_u32 s49, s49, s51
    s_lshr_b32 s50, s2, 5
    s_lshl_b32 s52, s48, 10
    s_lshl_b32 s53, s48, 11
    s_lshl_b32 s54, s48, 16
    s_mul_i32 s55, s48, 768
    s_mul_i32 s56, s48, 22016
    s_waitcnt lgkmcnt(0)
    s_lshl_b32 s57, s50, 18
    s_add_u32 s16, s10, s57
    s_addc_u32 s17, s11, 0
    s_and_b32 s17, s17, 65535
    s_mov_b32 s18, 262144
    s_mov_b32 s19, 131072
    s_lshl_b32 s57, s49, 8
    s_sub_u32 s58, 4194304, s57
    s_add_u32 s20, s8, s57
    s_addc_u32 s21, s9, 0
    s_and_b32 s21, s21, 65535
    s_mov_b32 s22, s58
    s_mov_b32 s23, 131072
    s_lshl_b32 s59, s49, 5
    s_sub_u32 s58, 1409024, s59
    s_add_u32 s24, s12, s59
    s_addc_u32 s25, s13, 0
    s_and_b32 s25, s25, 65535
    s_mov_b32 s26, s58
    s_mov_b32 s27, 131072
    s_add_u32 s28, s14, s59
    s_addc_u32 s29, s15, 0
    s_and_b32 s29, s29, 65535
    s_mov_b32 s30, s58
    s_mov_b32 s31, 131072
    s_lshl_b32 s58, s49, 19
    s_add_u32 s32, s4, s58
    s_addc_u32 s33, s5, 0
    s_add_u32 s32, s32, 393216
    s_addc_u32 s33, s33, 0
    s_and_b32 s33, s33, 65535
    s_mov_b32 s34, 131072
    s_mov_b32 s35, 131072
    s_add_u32 s36, s6, s58
    s_addc_u32 s37, s7, 0
    s_add_u32 s36, s36, 393216
    s_addc_u32 s37, s37, 0
    s_and_b32 s37, s37, 65535
    s_mov_b32 s38, 131072
    s_mov_b32 s39, 131072
    s_lshl_b32 s58, s50, 21
    s_lshl_b32 s57, s49, 13
    s_add_u32 s58, s58, s57
    s_sub_u32 s60, 2097152, s57
    s_add_u32 s40, s10, s58
    s_addc_u32 s41, s11, 0
    s_add_u32 s40, s40, 2097152
    s_addc_u32 s41, s41, 0
    s_and_b32 s41, s41, 65535
    s_mov_b32 s42, s60
    s_mov_b32 s43, 131072
    s_mul_i32 s58, s50, 720896
    s_add_u32 s44, s10, s58
    s_addc_u32 s45, s11, 0
    s_add_u32 s44, s44, 18874368
    s_addc_u32 s45, s45, 0
    s_and_b32 s45, s45, 65535
    s_mov_b32 s46, 720896
    s_mov_b32 s47, 131072
    s_and_b32 s57, s2, 3
    s_mul_i32 s58, s57, 1409024
    s_add_u32 s4, s96, s58
    s_addc_u32 s5, s97, 0
    s_sub_u32 s6, 4194304, s58
    s_cmp_eq_u32 s57, 3
    s_cselect_b32 s4, s98, s4
    s_cselect_b32 s5, s99, s5
    s_cselect_b32 s6, 1409024, s6
    s_and_b32 s5, s5, 65535
    s_mov_b32 s7, 131072
    s_lshr_b32 s58, s2, 3
    s_lshl_b32 s58, s58, 3
    s_add_u32 s58, s58, s48
    s_mul_i32 s97, s58, 5632
    v_lshrrev_b32 v15, 5, v1
    s_lshl_b32 s57, s48, 15
    v_lshl_add_u32 v2, v1, 4, s57
    v_lshrrev_b32 v7, 4, v1
    v_bfe_u32 v13, v1, 2, 2
    v_xor_b32 v13, v13, v7
    v_lshlrev_b32 v13, 6, v13
    v_and_b32 v14, 3, v1
    v_lshl_add_u32 v13, v14, 4, v13
    v_lshl_add_u32 v3, v7, 13, v13
    v_lshl_add_u32 v6, v7, 8, v13
    s_and_b32 s57, s48, 3
    s_lshl_b32 s57, s57, 2
    v_add_u32 v13, s57, v7
    v_and_b32 v14, 15, v1
    v_xor_b32 v13, v13, v14
    v_lshlrev_b32 v13, 4, v13
    v_lshl_add_u32 v5, v7, 8, v13
    v_mul_u32_u24 v7, 43, v1
    v_lshrrev_b32 v7, 8, v7
    v_mul_u32_u24 v13, 6, v7
    v_sub_u32 v13, v1, v13
    v_mul_u32_u24 v7, 2752, v7
    v_lshrrev_b32 v14, 1, v13
    v_lshl_add_u32 v7, v14, 10, v7
    v_and_b32 v13, 1, v13
    v_lshl_add_u32 v4, v13, 4, v7
    v_bfe_u32 v7, v1, 2, 2
    v_and_b32 v14, 1, v1
    v_lshlrev_b32 v13, 4, v14
    v_and_b32 v14, 2, v1
    v_lshl_add_u32 v13, v14, 2, v13
    v_bfe_u32 v14, v1, 4, 1
    v_lshl_add_u32 v13, v14, 5, v13
    v_mul_u32_u24 v12, 6240, v14
    v_add_u32 v12, v12, v13
    v_lshl_add_u32 v14, v15, 3, v7
    v_mul_u32_u24 v14, 96, v14
    v_add_u32 v12, v12, v14
    v_add_u32 v12, 16384, v12
    v_lshl_add_u32 v14, v15, 3, v7
    v_lshl_add_u32 v13, v14, 8, v13
    v_xor_b32 v14, 0, v7
    v_lshl_add_u32 v8, v14, 6, v13
    v_xor_b32 v14, 1, v7
    v_lshl_add_u32 v9, v14, 6, v13
    v_xor_b32 v14, 2, v7
    v_lshl_add_u32 v10, v14, 6, v13
    v_xor_b32 v14, 3, v7
    v_lshl_add_u32 v11, v14, 6, v13
    s_and_b32 s90, s49, 3
    s_lshl_b32 s90, s90, 1
    s_add_u32 s90, s90, s50
    s_add_u32 s91, s49, s50
    s_add_u32 s92, s90, 0
    s_and_b32 s92, s92, 7
    s_lshl_b32 s93, s92, 19
    s_add_u32 s93, s93, s54
    s_add_u32 m0, s53, 0
    s_add_u32 s61, s93, 0
    buffer_load_dwordx4 v3, s[20:23], s61 offen lds
    s_add_u32 m0, s53, 1024
    s_add_u32 s61, s93, 32768
    buffer_load_dwordx4 v3, s[20:23], s61 offen lds
    s_mov_b32 exec_hi, 0xffff
    s_add_u32 m0, s55, 16384
    s_mul_i32 s61, s92, 176128
    s_add_u32 s61, s61, s56
    buffer_load_dwordx4 v4, s[24:27], s61 offen lds
    s_mov_b32 exec_hi, -1
    s_mov_b32 exec_hi, 0xffff
    s_add_u32 m0, s55, 22656
    s_mul_i32 s61, s92, 176128
    s_add_u32 s61, s61, s56
    buffer_load_dwordx4 v4, s[28:31], s61 offen lds
    s_mov_b32 exec_hi, -1
    s_add_u32 s65, s90, 0
    s_and_b32 s65, s65, 7
    s_lshl_b32 s65, s65, 12
    buffer_load_dwordx4 v[128:131], v2, s[16:19], s65 offen offset:0
    buffer_load_dwordx4 v[132:135], v2, s[16:19], s65 offen offset:1024
    buffer_load_dwordx4 v[136:139], v2, s[16:19], s65 offen offset:2048
    buffer_load_dwordx4 v[140:143], v2, s[16:19], s65 offen offset:3072
    s_add_u32 s92, s90, 1
    s_and_b32 s92, s92, 7
    s_lshl_b32 s93, s92, 19
    s_add_u32 s93, s93, s54
    s_add_u32 m0, s53, 32768
    s_add_u32 s61, s93, 0
    buffer_load_dwordx4 v3, s[20:23], s61 offen lds
    s_add_u32 m0, s53, 33792
    s_add_u32 s61, s93, 32768
    buffer_load_dwordx4 v3, s[20:23], s61 offen lds
    s_mov_b32 exec_hi, 0xffff
    s_add_u32 m0, s55, 49152
    s_mul_i32 s61, s92, 176128
    s_add_u32 s61, s61, s56
    buffer_load_dwordx4 v4, s[24:27], s61 offen lds
    s_mov_b32 exec_hi, -1
    s_mov_b32 exec_hi, 0xffff
    s_add_u32 m0, s55, 55424
    s_mul_i32 s61, s92, 176128
    s_add_u32 s61, s61, s56
    buffer_load_dwordx4 v4, s[28:31], s61 offen lds
    s_mov_b32 exec_hi, -1
    s_add_u32 s65, s90, 1
    s_and_b32 s65, s65, 7
    s_lshl_b32 s65, s65, 12
    buffer_load_dwordx4 v[144:147], v2, s[16:19], s65 offen offset:0
    buffer_load_dwordx4 v[148:151], v2, s[16:19], s65 offen offset:1024
    buffer_load_dwordx4 v[152:155], v2, s[16:19], s65 offen offset:2048
    buffer_load_dwordx4 v[156:159], v2, s[16:19], s65 offen offset:3072
    s_waitcnt vmcnt(12)
    s_barrier
    s_add_u32 s92, s90, 2
    s_and_b32 s92, s92, 7
    s_lshl_b32 s93, s92, 19
    s_add_u32 s93, s93, s54
    s_add_u32 m0, s53, 65536
    s_add_u32 s61, s93, 0
    buffer_load_dwordx4 v3, s[20:23], s61 offen lds
    s_add_u32 m0, s53, 66560
    s_add_u32 s61, s93, 32768
    buffer_load_dwordx4 v3, s[20:23], s61 offen lds
    s_mov_b32 exec_hi, 0xffff
    s_add_u32 m0, s55, 81920
    s_mul_i32 s61, s92, 176128
    s_add_u32 s61, s61, s56
    buffer_load_dwordx4 v4, s[24:27], s61 offen lds
    s_mov_b32 exec_hi, -1
    s_mov_b32 exec_hi, 0xffff
    s_add_u32 m0, s55, 88192
    s_mul_i32 s61, s92, 176128
    s_add_u32 s61, s61, s56
    buffer_load_dwordx4 v4, s[28:31], s61 offen lds
    s_mov_b32 exec_hi, -1
    s_add_u32 s92, s90, 3
    s_and_b32 s92, s92, 7
    s_lshl_b32 s93, s92, 19
    s_add_u32 s93, s93, s54
    s_add_u32 m0, s53, 98304
    s_add_u32 s61, s93, 0
    buffer_load_dwordx4 v3, s[20:23], s61 offen lds
    s_add_u32 m0, s53, 99328
    s_add_u32 s61, s93, 32768
    buffer_load_dwordx4 v3, s[20:23], s61 offen lds
    s_mov_b32 exec_hi, 0xffff
    s_add_u32 m0, s55, 114688
    s_mul_i32 s61, s92, 176128
    s_add_u32 s61, s61, s56
    buffer_load_dwordx4 v4, s[24:27], s61 offen lds
    s_mov_b32 exec_hi, -1
    s_mov_b32 exec_hi, 0xffff
    s_add_u32 m0, s55, 120960
    s_mul_i32 s61, s92, 176128
    s_add_u32 s61, s61, s56
    buffer_load_dwordx4 v4, s[28:31], s61 offen lds
    s_mov_b32 exec_hi, -1
    ds_read_b64_tr_b16 v[176:177], v8 offset:0
    ds_read_b64_tr_b16 v[178:179], v8 offset:1024
    ds_read_b64_tr_b16 v[180:181], v9 offset:0
    ds_read_b64_tr_b16 v[182:183], v9 offset:1024
    ds_read_b64_tr_b16 v[184:185], v10 offset:0
    ds_read_b64_tr_b16 v[186:187], v10 offset:1024
    ds_read_b64_tr_b16 v[188:189], v11 offset:0
    ds_read_b64_tr_b16 v[190:191], v11 offset:1024
    ds_read_b64_tr_b16 v[192:193], v12 offset:0
    ds_read_b64_tr_b16 v[194:195], v12 offset:384
    ds_read_b64_tr_b16 v[196:197], v12 offset:32
    ds_read_b64_tr_b16 v[198:199], v12 offset:416
    ds_read_b64_tr_b16 v[200:201], v12 offset:64
    ds_read_b64_tr_b16 v[202:203], v12 offset:448
    s_waitcnt vmcnt(16)
    s_waitcnt lgkmcnt(12)
    v_mfma_f32_32x32x16_bf16 v[16:31], v[176:179], v[128:131], 0
    ds_read_b64_tr_b16 v[204:205], v8 offset:4096
    ds_read_b64_tr_b16 v[206:207], v8 offset:5120
    s_waitcnt lgkmcnt(12)
    v_mfma_f32_32x32x16_bf16 v[32:47], v[180:183], v[128:131], 0
    ds_read_b64_tr_b16 v[208:209], v9 offset:4096
    ds_read_b64_tr_b16 v[210:211], v9 offset:5120
    s_waitcnt lgkmcnt(12)
    v_mfma_f32_32x32x16_bf16 v[48:63], v[184:187], v[128:131], 0
    ds_read_b64_tr_b16 v[212:213], v10 offset:4096
    ds_read_b64_tr_b16 v[214:215], v10 offset:5120
    s_waitcnt lgkmcnt(12)
    v_mfma_f32_32x32x16_bf16 v[64:79], v[188:191], v[128:131], 0
    ds_read_b64_tr_b16 v[216:217], v11 offset:4096
    ds_read_b64_tr_b16 v[218:219], v11 offset:5120
    s_waitcnt lgkmcnt(12)
    v_mfma_f32_32x32x16_bf16 v[80:95], v[192:195], v[128:131], 0
    ds_read_b64_tr_b16 v[220:221], v12 offset:1536
    ds_read_b64_tr_b16 v[222:223], v12 offset:1920
    s_waitcnt lgkmcnt(12)
    v_mfma_f32_32x32x16_bf16 v[96:111], v[196:199], v[128:131], 0
    ds_read_b64_tr_b16 v[224:225], v12 offset:1568
    ds_read_b64_tr_b16 v[226:227], v12 offset:1952
    s_waitcnt lgkmcnt(12)
    v_mfma_f32_32x32x16_bf16 v[112:127], v[200:203], v[128:131], 0
    ds_read_b64_tr_b16 v[228:229], v12 offset:1600
    ds_read_b64_tr_b16 v[230:231], v12 offset:1984
    s_waitcnt lgkmcnt(12)
    v_mfma_f32_32x32x16_bf16 v[16:31], v[204:207], v[132:135], v[16:31]
    ds_read_b64_tr_b16 v[176:177], v8 offset:8192
    ds_read_b64_tr_b16 v[178:179], v8 offset:9216
    s_waitcnt lgkmcnt(12)
    v_mfma_f32_32x32x16_bf16 v[32:47], v[208:211], v[132:135], v[32:47]
    ds_read_b64_tr_b16 v[180:181], v9 offset:8192
    ds_read_b64_tr_b16 v[182:183], v9 offset:9216
    s_waitcnt lgkmcnt(12)
    v_mfma_f32_32x32x16_bf16 v[48:63], v[212:215], v[132:135], v[48:63]
    ds_read_b64_tr_b16 v[184:185], v10 offset:8192
    ds_read_b64_tr_b16 v[186:187], v10 offset:9216
    s_waitcnt lgkmcnt(12)
    v_mfma_f32_32x32x16_bf16 v[64:79], v[216:219], v[132:135], v[64:79]
    ds_read_b64_tr_b16 v[188:189], v11 offset:8192
    ds_read_b64_tr_b16 v[190:191], v11 offset:9216
    s_waitcnt lgkmcnt(12)
    v_mfma_f32_32x32x16_bf16 v[80:95], v[220:223], v[132:135], v[80:95]
    ds_read_b64_tr_b16 v[192:193], v12 offset:3072
    ds_read_b64_tr_b16 v[194:195], v12 offset:3456
    s_waitcnt lgkmcnt(12)
    v_mfma_f32_32x32x16_bf16 v[96:111], v[224:227], v[132:135], v[96:111]
    ds_read_b64_tr_b16 v[196:197], v12 offset:3104
    ds_read_b64_tr_b16 v[198:199], v12 offset:3488
    s_waitcnt lgkmcnt(12)
    v_mfma_f32_32x32x16_bf16 v[112:127], v[228:231], v[132:135], v[112:127]
    ds_read_b64_tr_b16 v[200:201], v12 offset:3136
    ds_read_b64_tr_b16 v[202:203], v12 offset:3520
    s_waitcnt lgkmcnt(12)
    v_mfma_f32_32x32x16_bf16 v[16:31], v[176:179], v[136:139], v[16:31]
    ds_read_b64_tr_b16 v[204:205], v8 offset:12288
    ds_read_b64_tr_b16 v[206:207], v8 offset:13312
    s_waitcnt lgkmcnt(12)
    v_mfma_f32_32x32x16_bf16 v[32:47], v[180:183], v[136:139], v[32:47]
    ds_read_b64_tr_b16 v[208:209], v9 offset:12288
    ds_read_b64_tr_b16 v[210:211], v9 offset:13312
    s_waitcnt lgkmcnt(12)
    v_mfma_f32_32x32x16_bf16 v[48:63], v[184:187], v[136:139], v[48:63]
    ds_read_b64_tr_b16 v[212:213], v10 offset:12288
    ds_read_b64_tr_b16 v[214:215], v10 offset:13312
    s_waitcnt lgkmcnt(12)
    v_mfma_f32_32x32x16_bf16 v[64:79], v[188:191], v[136:139], v[64:79]
    ds_read_b64_tr_b16 v[216:217], v11 offset:12288
    ds_read_b64_tr_b16 v[218:219], v11 offset:13312
    s_waitcnt lgkmcnt(12)
    v_mfma_f32_32x32x16_bf16 v[80:95], v[192:195], v[136:139], v[80:95]
    ds_read_b64_tr_b16 v[220:221], v12 offset:4608
    ds_read_b64_tr_b16 v[222:223], v12 offset:4992
    s_waitcnt lgkmcnt(12)
    v_mfma_f32_32x32x16_bf16 v[96:111], v[196:199], v[136:139], v[96:111]
    ds_read_b64_tr_b16 v[224:225], v12 offset:4640
    ds_read_b64_tr_b16 v[226:227], v12 offset:5024
    s_waitcnt lgkmcnt(12)
    v_mfma_f32_32x32x16_bf16 v[112:127], v[200:203], v[136:139], v[112:127]
    ds_read_b64_tr_b16 v[228:229], v12 offset:4672
    ds_read_b64_tr_b16 v[230:231], v12 offset:5056
    s_waitcnt vmcnt(12)
    s_barrier
    v_add_u32 v8, 32768, v8
    v_add_u32 v9, 32768, v9
    v_add_u32 v10, 32768, v10
    v_add_u32 v11, 32768, v11
    v_add_u32 v12, 32768, v12
    s_waitcnt lgkmcnt(12)
    v_mfma_f32_32x32x16_bf16 v[16:31], v[204:207], v[140:143], v[16:31]
    ds_read_b64_tr_b16 v[176:177], v8 offset:0
    ds_read_b64_tr_b16 v[178:179], v8 offset:1024
    s_waitcnt lgkmcnt(12)
    v_mfma_f32_32x32x16_bf16 v[32:47], v[208:211], v[140:143], v[32:47]
    ds_read_b64_tr_b16 v[180:181], v9 offset:0
    ds_read_b64_tr_b16 v[182:183], v9 offset:1024
    s_add_u32 s65, s90, 2
    s_and_b32 s65, s65, 7
    s_lshl_b32 s65, s65, 12
    buffer_load_dwordx4 v[160:163], v2, s[16:19], s65 offen offset:0
    s_waitcnt lgkmcnt(12)
    v_mfma_f32_32x32x16_bf16 v[48:63], v[212:215], v[140:143], v[48:63]
    ds_read_b64_tr_b16 v[184:185], v10 offset:0
    ds_read_b64_tr_b16 v[186:187], v10 offset:1024
    s_waitcnt lgkmcnt(12)
    v_mfma_f32_32x32x16_bf16 v[64:79], v[216:219], v[140:143], v[64:79]
    ds_read_b64_tr_b16 v[188:189], v11 offset:0
    ds_read_b64_tr_b16 v[190:191], v11 offset:1024
    s_waitcnt lgkmcnt(12)
    v_mfma_f32_32x32x16_bf16 v[80:95], v[220:223], v[140:143], v[80:95]
    ds_read_b64_tr_b16 v[192:193], v12 offset:0
    ds_read_b64_tr_b16 v[194:195], v12 offset:384
    buffer_load_dwordx4 v[164:167], v2, s[16:19], s65 offen offset:1024
    s_waitcnt lgkmcnt(12)
    v_mfma_f32_32x32x16_bf16 v[96:111], v[224:227], v[140:143], v[96:111]
    ds_read_b64_tr_b16 v[196:197], v12 offset:32
    ds_read_b64_tr_b16 v[198:199], v12 offset:416
    s_waitcnt lgkmcnt(12)
    v_mfma_f32_32x32x16_bf16 v[112:127], v[228:231], v[140:143], v[112:127]
    ds_read_b64_tr_b16 v[200:201], v12 offset:64
    ds_read_b64_tr_b16 v[202:203], v12 offset:448
    s_waitcnt vmcnt(10)
    s_waitcnt lgkmcnt(12)
    v_mfma_f32_32x32x16_bf16 v[16:31], v[176:179], v[144:147], v[16:31]
    ds_read_b64_tr_b16 v[204:205], v8 offset:4096
    ds_read_b64_tr_b16 v[206:207], v8 offset:5120
    s_waitcnt lgkmcnt(12)
    v_mfma_f32_32x32x16_bf16 v[32:47], v[180:183], v[144:147], v[32:47]
    ds_read_b64_tr_b16 v[208:209], v9 offset:4096
    ds_read_b64_tr_b16 v[210:211], v9 offset:5120
    buffer_load_dwordx4 v[168:171], v2, s[16:19], s65 offen offset:2048
    s_waitcnt lgkmcnt(12)
    v_mfma_f32_32x32x16_bf16 v[48:63], v[184:187], v[144:147], v[48:63]
    ds_read_b64_tr_b16 v[212:213], v10 offset:4096
    ds_read_b64_tr_b16 v[214:215], v10 offset:5120
    s_waitcnt lgkmcnt(12)
    v_mfma_f32_32x32x16_bf16 v[64:79], v[188:191], v[144:147], v[64:79]
    ds_read_b64_tr_b16 v[216:217], v11 offset:4096
    ds_read_b64_tr_b16 v[218:219], v11 offset:5120
    s_waitcnt lgkmcnt(12)
    v_mfma_f32_32x32x16_bf16 v[80:95], v[192:195], v[144:147], v[80:95]
    ds_read_b64_tr_b16 v[220:221], v12 offset:1536
    ds_read_b64_tr_b16 v[222:223], v12 offset:1920
    buffer_load_dwordx4 v[172:175], v2, s[16:19], s65 offen offset:3072
    s_waitcnt lgkmcnt(12)
    v_mfma_f32_32x32x16_bf16 v[96:111], v[196:199], v[144:147], v[96:111]
    ds_read_b64_tr_b16 v[224:225], v12 offset:1568
    ds_read_b64_tr_b16 v[226:227], v12 offset:1952
    s_waitcnt lgkmcnt(12)
    v_mfma_f32_32x32x16_bf16 v[112:127], v[200:203], v[144:147], v[112:127]
    ds_read_b64_tr_b16 v[228:229], v12 offset:1600
    ds_read_b64_tr_b16 v[230:231], v12 offset:1984
    s_waitcnt lgkmcnt(12)
    v_mfma_f32_32x32x16_bf16 v[16:31], v[204:207], v[148:151], v[16:31]
    ds_read_b64_tr_b16 v[176:177], v8 offset:8192
    ds_read_b64_tr_b16 v[178:179], v8 offset:9216
    s_waitcnt lgkmcnt(12)
    v_mfma_f32_32x32x16_bf16 v[32:47], v[208:211], v[148:151], v[32:47]
    ds_read_b64_tr_b16 v[180:181], v9 offset:8192
    ds_read_b64_tr_b16 v[182:183], v9 offset:9216
    s_add_u32 s92, s90, 4
    s_and_b32 s92, s92, 7
    s_lshl_b32 s93, s92, 19
    s_add_u32 s93, s93, s54
    s_add_u32 m0, s53, 131072
    s_add_u32 s61, s93, 0
    buffer_load_dwordx4 v3, s[20:23], s61 offen lds
    s_waitcnt lgkmcnt(12)
    v_mfma_f32_32x32x16_bf16 v[48:63], v[212:215], v[148:151], v[48:63]
    ds_read_b64_tr_b16 v[184:185], v10 offset:8192
    ds_read_b64_tr_b16 v[186:187], v10 offset:9216
    s_waitcnt lgkmcnt(12)
    v_mfma_f32_32x32x16_bf16 v[64:79], v[216:219], v[148:151], v[64:79]
    ds_read_b64_tr_b16 v[188:189], v11 offset:8192
    ds_read_b64_tr_b16 v[190:191], v11 offset:9216
    s_waitcnt lgkmcnt(12)
    v_mfma_f32_32x32x16_bf16 v[80:95], v[220:223], v[148:151], v[80:95]
    ds_read_b64_tr_b16 v[192:193], v12 offset:3072
    ds_read_b64_tr_b16 v[194:195], v12 offset:3456
    s_add_u32 m0, s53, 132096
    s_add_u32 s61, s93, 32768
    buffer_load_dwordx4 v3, s[20:23], s61 offen lds
    s_waitcnt lgkmcnt(12)
    v_mfma_f32_32x32x16_bf16 v[96:111], v[224:227], v[148:151], v[96:111]
    ds_read_b64_tr_b16 v[196:197], v12 offset:3104
    ds_read_b64_tr_b16 v[198:199], v12 offset:3488
    s_waitcnt lgkmcnt(12)
    v_mfma_f32_32x32x16_bf16 v[112:127], v[228:231], v[148:151], v[112:127]
    ds_read_b64_tr_b16 v[200:201], v12 offset:3136
    ds_read_b64_tr_b16 v[202:203], v12 offset:3520
    s_waitcnt lgkmcnt(12)
    v_mfma_f32_32x32x16_bf16 v[16:31], v[176:179], v[152:155], v[16:31]
    ds_read_b64_tr_b16 v[204:205], v8 offset:12288
    ds_read_b64_tr_b16 v[206:207], v8 offset:13312
    s_waitcnt lgkmcnt(12)
    v_mfma_f32_32x32x16_bf16 v[32:47], v[180:183], v[152:155], v[32:47]
    ds_read_b64_tr_b16 v[208:209], v9 offset:12288
    ds_read_b64_tr_b16 v[210:211], v9 offset:13312
    s_mov_b32 exec_hi, 0xffff
    s_add_u32 m0, s55, 147456
    s_mul_i32 s61, s92, 176128
    s_add_u32 s61, s61, s56
    buffer_load_dwordx4 v4, s[24:27], s61 offen lds
    s_mov_b32 exec_hi, -1
    s_waitcnt lgkmcnt(12)
    v_mfma_f32_32x32x16_bf16 v[48:63], v[184:187], v[152:155], v[48:63]
    ds_read_b64_tr_b16 v[212:213], v10 offset:12288
    ds_read_b64_tr_b16 v[214:215], v10 offset:13312
    s_waitcnt lgkmcnt(12)
    v_mfma_f32_32x32x16_bf16 v[64:79], v[188:191], v[152:155], v[64:79]
    ds_read_b64_tr_b16 v[216:217], v11 offset:12288
    ds_read_b64_tr_b16 v[218:219], v11 offset:13312
    s_waitcnt lgkmcnt(12)
    v_mfma_f32_32x32x16_bf16 v[80:95], v[192:195], v[152:155], v[80:95]
    ds_read_b64_tr_b16 v[220:221], v12 offset:4608
    ds_read_b64_tr_b16 v[222:223], v12 offset:4992
    s_mov_b32 exec_hi, 0xffff
    s_add_u32 m0, s55, 153728
    s_mul_i32 s61, s92, 176128
    s_add_u32 s61, s61, s56
    buffer_load_dwordx4 v4, s[28:31], s61 offen lds
    s_mov_b32 exec_hi, -1
    s_waitcnt lgkmcnt(12)
    v_mfma_f32_32x32x16_bf16 v[96:111], v[196:199], v[152:155], v[96:111]
    ds_read_b64_tr_b16 v[224:225], v12 offset:4640
    ds_read_b64_tr_b16 v[226:227], v12 offset:5024
    s_waitcnt lgkmcnt(12)
    v_mfma_f32_32x32x16_bf16 v[112:127], v[200:203], v[152:155], v[112:127]
    ds_read_b64_tr_b16 v[228:229], v12 offset:4672
    ds_read_b64_tr_b16 v[230:231], v12 offset:5056
    s_waitcnt vmcnt(12)
    s_barrier
    v_add_u32 v8, 32768, v8
    v_add_u32 v9, 32768, v9
    v_add_u32 v10, 32768, v10
    v_add_u32 v11, 32768, v11
    v_add_u32 v12, 32768, v12
    s_waitcnt lgkmcnt(12)
    v_mfma_f32_32x32x16_bf16 v[16:31], v[204:207], v[156:159], v[16:31]
    ds_read_b64_tr_b16 v[176:177], v8 offset:0
    ds_read_b64_tr_b16 v[178:179], v8 offset:1024
    s_waitcnt lgkmcnt(12)
    v_mfma_f32_32x32x16_bf16 v[32:47], v[208:211], v[156:159], v[32:47]
    ds_read_b64_tr_b16 v[180:181], v9 offset:0
    ds_read_b64_tr_b16 v[182:183], v9 offset:1024
    s_add_u32 s65, s90, 3
    s_and_b32 s65, s65, 7
    s_lshl_b32 s65, s65, 12
    buffer_load_dwordx4 v[128:131], v2, s[16:19], s65 offen offset:0
    s_waitcnt lgkmcnt(12)
    v_mfma_f32_32x32x16_bf16 v[48:63], v[212:215], v[156:159], v[48:63]
    ds_read_b64_tr_b16 v[184:185], v10 offset:0
    ds_read_b64_tr_b16 v[186:187], v10 offset:1024
    s_waitcnt lgkmcnt(12)
    v_mfma_f32_32x32x16_bf16 v[64:79], v[216:219], v[156:159], v[64:79]
    ds_read_b64_tr_b16 v[188:189], v11 offset:0
    ds_read_b64_tr_b16 v[190:191], v11 offset:1024
    s_waitcnt lgkmcnt(12)
    v_mfma_f32_32x32x16_bf16 v[80:95], v[220:223], v[156:159], v[80:95]
    ds_read_b64_tr_b16 v[192:193], v12 offset:0
    ds_read_b64_tr_b16 v[194:195], v12 offset:384
    buffer_load_dwordx4 v[132:135], v2, s[16:19], s65 offen offset:1024
    s_waitcnt lgkmcnt(12)
    v_mfma_f32_32x32x16_bf16 v[96:111], v[224:227], v[156:159], v[96:111]
    ds_read_b64_tr_b16 v[196:197], v12 offset:32
    ds_read_b64_tr_b16 v[198:199], v12 offset:416
    s_waitcnt lgkmcnt(12)
    v_mfma_f32_32x32x16_bf16 v[112:127], v[228:231], v[156:159], v[112:127]
    ds_read_b64_tr_b16 v[200:201], v12 offset:64
    ds_read_b64_tr_b16 v[202:203], v12 offset:448
    s_waitcnt vmcnt(6)
    s_waitcnt lgkmcnt(12)
    v_mfma_f32_32x32x16_bf16 v[16:31], v[176:179], v[160:163], v[16:31]
    ds_read_b64_tr_b16 v[204:205], v8 offset:4096
    ds_read_b64_tr_b16 v[206:207], v8 offset:5120
    s_waitcnt lgkmcnt(12)
    v_mfma_f32_32x32x16_bf16 v[32:47], v[180:183], v[160:163], v[32:47]
    ds_read_b64_tr_b16 v[208:209], v9 offset:4096
    ds_read_b64_tr_b16 v[210:211], v9 offset:5120
    buffer_load_dwordx4 v[136:139], v2, s[16:19], s65 offen offset:2048
    s_waitcnt lgkmcnt(12)
    v_mfma_f32_32x32x16_bf16 v[48:63], v[184:187], v[160:163], v[48:63]
    ds_read_b64_tr_b16 v[212:213], v10 offset:4096
    ds_read_b64_tr_b16 v[214:215], v10 offset:5120
    s_waitcnt lgkmcnt(12)
    v_mfma_f32_32x32x16_bf16 v[64:79], v[188:191], v[160:163], v[64:79]
    ds_read_b64_tr_b16 v[216:217], v11 offset:4096
    ds_read_b64_tr_b16 v[218:219], v11 offset:5120
    s_waitcnt lgkmcnt(12)
    v_mfma_f32_32x32x16_bf16 v[80:95], v[192:195], v[160:163], v[80:95]
    ds_read_b64_tr_b16 v[220:221], v12 offset:1536
    ds_read_b64_tr_b16 v[222:223], v12 offset:1920
    buffer_load_dwordx4 v[140:143], v2, s[16:19], s65 offen offset:3072
    s_waitcnt lgkmcnt(12)
    v_mfma_f32_32x32x16_bf16 v[96:111], v[196:199], v[160:163], v[96:111]
    ds_read_b64_tr_b16 v[224:225], v12 offset:1568
    ds_read_b64_tr_b16 v[226:227], v12 offset:1952
    s_waitcnt lgkmcnt(12)
    v_mfma_f32_32x32x16_bf16 v[112:127], v[200:203], v[160:163], v[112:127]
    ds_read_b64_tr_b16 v[228:229], v12 offset:1600
    ds_read_b64_tr_b16 v[230:231], v12 offset:1984
    s_waitcnt lgkmcnt(12)
    v_mfma_f32_32x32x16_bf16 v[16:31], v[204:207], v[164:167], v[16:31]
    ds_read_b64_tr_b16 v[176:177], v8 offset:8192
    ds_read_b64_tr_b16 v[178:179], v8 offset:9216
    s_waitcnt lgkmcnt(12)
    v_mfma_f32_32x32x16_bf16 v[32:47], v[208:211], v[164:167], v[32:47]
    ds_read_b64_tr_b16 v[180:181], v9 offset:8192
    ds_read_b64_tr_b16 v[182:183], v9 offset:9216
    s_add_u32 s92, s90, 5
    s_and_b32 s92, s92, 7
    s_lshl_b32 s93, s92, 19
    s_add_u32 s93, s93, s54
    s_add_u32 m0, s53, 0
    s_add_u32 s61, s93, 0
    buffer_load_dwordx4 v3, s[20:23], s61 offen lds
    s_waitcnt lgkmcnt(12)
    v_mfma_f32_32x32x16_bf16 v[48:63], v[212:215], v[164:167], v[48:63]
    ds_read_b64_tr_b16 v[184:185], v10 offset:8192
    ds_read_b64_tr_b16 v[186:187], v10 offset:9216
    s_waitcnt lgkmcnt(12)
    v_mfma_f32_32x32x16_bf16 v[64:79], v[216:219], v[164:167], v[64:79]
    ds_read_b64_tr_b16 v[188:189], v11 offset:8192
    ds_read_b64_tr_b16 v[190:191], v11 offset:9216
    s_waitcnt lgkmcnt(12)
    v_mfma_f32_32x32x16_bf16 v[80:95], v[220:223], v[164:167], v[80:95]
    ds_read_b64_tr_b16 v[192:193], v12 offset:3072
    ds_read_b64_tr_b16 v[194:195], v12 offset:3456
    s_add_u32 m0, s53, 1024
    s_add_u32 s61, s93, 32768
    buffer_load_dwordx4 v3, s[20:23], s61 offen lds
    s_waitcnt lgkmcnt(12)
    v_mfma_f32_32x32x16_bf16 v[96:111], v[224:227], v[164:167], v[96:111]
    ds_read_b64_tr_b16 v[196:197], v12 offset:3104
    ds_read_b64_tr_b16 v[198:199], v12 offset:3488
    s_waitcnt lgkmcnt(12)
    v_mfma_f32_32x32x16_bf16 v[112:127], v[228:231], v[164:167], v[112:127]
    ds_read_b64_tr_b16 v[200:201], v12 offset:3136
    ds_read_b64_tr_b16 v[202:203], v12 offset:3520
    s_waitcnt lgkmcnt(12)
    v_mfma_f32_32x32x16_bf16 v[16:31], v[176:179], v[168:171], v[16:31]
    ds_read_b64_tr_b16 v[204:205], v8 offset:12288
    ds_read_b64_tr_b16 v[206:207], v8 offset:13312
    s_waitcnt lgkmcnt(12)
    v_mfma_f32_32x32x16_bf16 v[32:47], v[180:183], v[168:171], v[32:47]
    ds_read_b64_tr_b16 v[208:209], v9 offset:12288
    ds_read_b64_tr_b16 v[210:211], v9 offset:13312
    s_mov_b32 exec_hi, 0xffff
    s_add_u32 m0, s55, 16384
    s_mul_i32 s61, s92, 176128
    s_add_u32 s61, s61, s56
    buffer_load_dwordx4 v4, s[24:27], s61 offen lds
    s_mov_b32 exec_hi, -1
    s_waitcnt lgkmcnt(12)
    v_mfma_f32_32x32x16_bf16 v[48:63], v[184:187], v[168:171], v[48:63]
    ds_read_b64_tr_b16 v[212:213], v10 offset:12288
    ds_read_b64_tr_b16 v[214:215], v10 offset:13312
    s_waitcnt lgkmcnt(12)
    v_mfma_f32_32x32x16_bf16 v[64:79], v[188:191], v[168:171], v[64:79]
    ds_read_b64_tr_b16 v[216:217], v11 offset:12288
    ds_read_b64_tr_b16 v[218:219], v11 offset:13312
    s_waitcnt lgkmcnt(12)
    v_mfma_f32_32x32x16_bf16 v[80:95], v[192:195], v[168:171], v[80:95]
    ds_read_b64_tr_b16 v[220:221], v12 offset:4608
    ds_read_b64_tr_b16 v[222:223], v12 offset:4992
    s_mov_b32 exec_hi, 0xffff
    s_add_u32 m0, s55, 22656
    s_mul_i32 s61, s92, 176128
    s_add_u32 s61, s61, s56
    buffer_load_dwordx4 v4, s[28:31], s61 offen lds
    s_mov_b32 exec_hi, -1
    s_waitcnt lgkmcnt(12)
    v_mfma_f32_32x32x16_bf16 v[96:111], v[196:199], v[168:171], v[96:111]
    ds_read_b64_tr_b16 v[224:225], v12 offset:4640
    ds_read_b64_tr_b16 v[226:227], v12 offset:5024
    s_waitcnt lgkmcnt(12)
    v_mfma_f32_32x32x16_bf16 v[112:127], v[200:203], v[168:171], v[112:127]
    ds_read_b64_tr_b16 v[228:229], v12 offset:4672
    ds_read_b64_tr_b16 v[230:231], v12 offset:5056
    s_barrier
    v_add_u32 v8, 32768, v8
    v_add_u32 v9, 32768, v9
    v_add_u32 v10, 32768, v10
    v_add_u32 v11, 32768, v11
    v_add_u32 v12, 32768, v12
    s_waitcnt lgkmcnt(12)
    v_mfma_f32_32x32x16_bf16 v[16:31], v[204:207], v[172:175], v[16:31]
    ds_read_b64_tr_b16 v[176:177], v8 offset:0
    ds_read_b64_tr_b16 v[178:179], v8 offset:1024
    s_waitcnt lgkmcnt(12)
    v_mfma_f32_32x32x16_bf16 v[32:47], v[208:211], v[172:175], v[32:47]
    ds_read_b64_tr_b16 v[180:181], v9 offset:0
    ds_read_b64_tr_b16 v[182:183], v9 offset:1024
    s_add_u32 s65, s90, 4
    s_and_b32 s65, s65, 7
    s_lshl_b32 s65, s65, 12
    buffer_load_dwordx4 v[144:147], v2, s[16:19], s65 offen offset:0
    s_waitcnt lgkmcnt(12)
    v_mfma_f32_32x32x16_bf16 v[48:63], v[212:215], v[172:175], v[48:63]
    ds_read_b64_tr_b16 v[184:185], v10 offset:0
    ds_read_b64_tr_b16 v[186:187], v10 offset:1024
    s_waitcnt lgkmcnt(12)
    v_mfma_f32_32x32x16_bf16 v[64:79], v[216:219], v[172:175], v[64:79]
    ds_read_b64_tr_b16 v[188:189], v11 offset:0
    ds_read_b64_tr_b16 v[190:191], v11 offset:1024
    s_waitcnt lgkmcnt(12)
    v_mfma_f32_32x32x16_bf16 v[80:95], v[220:223], v[172:175], v[80:95]
    ds_read_b64_tr_b16 v[192:193], v12 offset:0
    ds_read_b64_tr_b16 v[194:195], v12 offset:384
    buffer_load_dwordx4 v[148:151], v2, s[16:19], s65 offen offset:1024
    s_waitcnt lgkmcnt(12)
    v_mfma_f32_32x32x16_bf16 v[96:111], v[224:227], v[172:175], v[96:111]
    ds_read_b64_tr_b16 v[196:197], v12 offset:32
    ds_read_b64_tr_b16 v[198:199], v12 offset:416
    s_waitcnt lgkmcnt(12)
    v_mfma_f32_32x32x16_bf16 v[112:127], v[228:231], v[172:175], v[112:127]
    ds_read_b64_tr_b16 v[200:201], v12 offset:64
    ds_read_b64_tr_b16 v[202:203], v12 offset:448
    s_waitcnt vmcnt(6)
    s_waitcnt lgkmcnt(12)
    v_mfma_f32_32x32x16_bf16 v[16:31], v[176:179], v[128:131], v[16:31]
    ds_read_b64_tr_b16 v[204:205], v8 offset:4096
    ds_read_b64_tr_b16 v[206:207], v8 offset:5120
    s_waitcnt lgkmcnt(12)
    v_mfma_f32_32x32x16_bf16 v[32:47], v[180:183], v[128:131], v[32:47]
    ds_read_b64_tr_b16 v[208:209], v9 offset:4096
    ds_read_b64_tr_b16 v[210:211], v9 offset:5120
    buffer_load_dwordx4 v[152:155], v2, s[16:19], s65 offen offset:2048
    s_waitcnt lgkmcnt(12)
    v_mfma_f32_32x32x16_bf16 v[48:63], v[184:187], v[128:131], v[48:63]
    ds_read_b64_tr_b16 v[212:213], v10 offset:4096
    ds_read_b64_tr_b16 v[214:215], v10 offset:5120
    s_waitcnt lgkmcnt(12)
    v_mfma_f32_32x32x16_bf16 v[64:79], v[188:191], v[128:131], v[64:79]
    ds_read_b64_tr_b16 v[216:217], v11 offset:4096
    ds_read_b64_tr_b16 v[218:219], v11 offset:5120
    s_waitcnt lgkmcnt(12)
    v_mfma_f32_32x32x16_bf16 v[80:95], v[192:195], v[128:131], v[80:95]
    ds_read_b64_tr_b16 v[220:221], v12 offset:1536
    ds_read_b64_tr_b16 v[222:223], v12 offset:1920
    buffer_load_dwordx4 v[156:159], v2, s[16:19], s65 offen offset:3072
    s_waitcnt lgkmcnt(12)
    v_mfma_f32_32x32x16_bf16 v[96:111], v[196:199], v[128:131], v[96:111]
    ds_read_b64_tr_b16 v[224:225], v12 offset:1568
    ds_read_b64_tr_b16 v[226:227], v12 offset:1952
    s_waitcnt lgkmcnt(12)
    v_mfma_f32_32x32x16_bf16 v[112:127], v[200:203], v[128:131], v[112:127]
    ds_read_b64_tr_b16 v[228:229], v12 offset:1600
    ds_read_b64_tr_b16 v[230:231], v12 offset:1984
    s_waitcnt lgkmcnt(12)
    v_mfma_f32_32x32x16_bf16 v[16:31], v[204:207], v[132:135], v[16:31]
    ds_read_b64_tr_b16 v[176:177], v8 offset:8192
    ds_read_b64_tr_b16 v[178:179], v8 offset:9216
    s_waitcnt lgkmcnt(12)
    v_mfma_f32_32x32x16_bf16 v[32:47], v[208:211], v[132:135], v[32:47]
    ds_read_b64_tr_b16 v[180:181], v9 offset:8192
    ds_read_b64_tr_b16 v[182:183], v9 offset:9216
    s_add_u32 s92, s90, 6
    s_and_b32 s92, s92, 7
    s_lshl_b32 s93, s92, 19
    s_add_u32 s93, s93, s54
    s_add_u32 m0, s53, 32768
    s_add_u32 s61, s93, 0
    buffer_load_dwordx4 v3, s[20:23], s61 offen lds
    s_waitcnt lgkmcnt(12)
    v_mfma_f32_32x32x16_bf16 v[48:63], v[212:215], v[132:135], v[48:63]
    ds_read_b64_tr_b16 v[184:185], v10 offset:8192
    ds_read_b64_tr_b16 v[186:187], v10 offset:9216
    s_waitcnt lgkmcnt(12)
    v_mfma_f32_32x32x16_bf16 v[64:79], v[216:219], v[132:135], v[64:79]
    ds_read_b64_tr_b16 v[188:189], v11 offset:8192
    ds_read_b64_tr_b16 v[190:191], v11 offset:9216
    s_waitcnt lgkmcnt(12)
    v_mfma_f32_32x32x16_bf16 v[80:95], v[220:223], v[132:135], v[80:95]
    ds_read_b64_tr_b16 v[192:193], v12 offset:3072
    ds_read_b64_tr_b16 v[194:195], v12 offset:3456
    s_add_u32 m0, s53, 33792
    s_add_u32 s61, s93, 32768
    buffer_load_dwordx4 v3, s[20:23], s61 offen lds
    s_waitcnt lgkmcnt(12)
    v_mfma_f32_32x32x16_bf16 v[96:111], v[224:227], v[132:135], v[96:111]
    ds_read_b64_tr_b16 v[196:197], v12 offset:3104
    ds_read_b64_tr_b16 v[198:199], v12 offset:3488
    s_waitcnt lgkmcnt(12)
    v_mfma_f32_32x32x16_bf16 v[112:127], v[228:231], v[132:135], v[112:127]
    ds_read_b64_tr_b16 v[200:201], v12 offset:3136
    ds_read_b64_tr_b16 v[202:203], v12 offset:3520
    s_waitcnt lgkmcnt(12)
    v_mfma_f32_32x32x16_bf16 v[16:31], v[176:179], v[136:139], v[16:31]
    ds_read_b64_tr_b16 v[204:205], v8 offset:12288
    ds_read_b64_tr_b16 v[206:207], v8 offset:13312
    s_waitcnt lgkmcnt(12)
    v_mfma_f32_32x32x16_bf16 v[32:47], v[180:183], v[136:139], v[32:47]
    ds_read_b64_tr_b16 v[208:209], v9 offset:12288
    ds_read_b64_tr_b16 v[210:211], v9 offset:13312
    s_mov_b32 exec_hi, 0xffff
    s_add_u32 m0, s55, 49152
    s_mul_i32 s61, s92, 176128
    s_add_u32 s61, s61, s56
    buffer_load_dwordx4 v4, s[24:27], s61 offen lds
    s_mov_b32 exec_hi, -1
    s_waitcnt lgkmcnt(12)
    v_mfma_f32_32x32x16_bf16 v[48:63], v[184:187], v[136:139], v[48:63]
    ds_read_b64_tr_b16 v[212:213], v10 offset:12288
    ds_read_b64_tr_b16 v[214:215], v10 offset:13312
    s_waitcnt lgkmcnt(12)
    v_mfma_f32_32x32x16_bf16 v[64:79], v[188:191], v[136:139], v[64:79]
    ds_read_b64_tr_b16 v[216:217], v11 offset:12288
    ds_read_b64_tr_b16 v[218:219], v11 offset:13312
    s_waitcnt lgkmcnt(12)
    v_mfma_f32_32x32x16_bf16 v[80:95], v[192:195], v[136:139], v[80:95]
    ds_read_b64_tr_b16 v[220:221], v12 offset:4608
    ds_read_b64_tr_b16 v[222:223], v12 offset:4992
    s_mov_b32 exec_hi, 0xffff
    s_add_u32 m0, s55, 55424
    s_mul_i32 s61, s92, 176128
    s_add_u32 s61, s61, s56
    buffer_load_dwordx4 v4, s[28:31], s61 offen lds
    s_mov_b32 exec_hi, -1
    s_waitcnt lgkmcnt(12)
    v_mfma_f32_32x32x16_bf16 v[96:111], v[196:199], v[136:139], v[96:111]
    ds_read_b64_tr_b16 v[224:225], v12 offset:4640
    ds_read_b64_tr_b16 v[226:227], v12 offset:5024
    s_waitcnt lgkmcnt(12)
    v_mfma_f32_32x32x16_bf16 v[112:127], v[200:203], v[136:139], v[112:127]
    ds_read_b64_tr_b16 v[228:229], v12 offset:4672
    ds_read_b64_tr_b16 v[230:231], v12 offset:5056
    s_barrier
    v_add_u32 v8, 32768, v8
    v_add_u32 v9, 32768, v9
    v_add_u32 v10, 32768, v10
    v_add_u32 v11, 32768, v11
    v_add_u32 v12, 32768, v12
    s_waitcnt lgkmcnt(12)
    v_mfma_f32_32x32x16_bf16 v[16:31], v[204:207], v[140:143], v[16:31]
    ds_read_b64_tr_b16 v[176:177], v8 offset:0
    ds_read_b64_tr_b16 v[178:179], v8 offset:1024
    s_waitcnt lgkmcnt(12)
    v_mfma_f32_32x32x16_bf16 v[32:47], v[208:211], v[140:143], v[32:47]
    ds_read_b64_tr_b16 v[180:181], v9 offset:0
    ds_read_b64_tr_b16 v[182:183], v9 offset:1024
    s_add_u32 s65, s90, 5
    s_and_b32 s65, s65, 7
    s_lshl_b32 s65, s65, 12
    buffer_load_dwordx4 v[160:163], v2, s[16:19], s65 offen offset:0
    s_waitcnt lgkmcnt(12)
    v_mfma_f32_32x32x16_bf16 v[48:63], v[212:215], v[140:143], v[48:63]
    ds_read_b64_tr_b16 v[184:185], v10 offset:0
    ds_read_b64_tr_b16 v[186:187], v10 offset:1024
    s_waitcnt lgkmcnt(12)
    v_mfma_f32_32x32x16_bf16 v[64:79], v[216:219], v[140:143], v[64:79]
    ds_read_b64_tr_b16 v[188:189], v11 offset:0
    ds_read_b64_tr_b16 v[190:191], v11 offset:1024
    s_waitcnt lgkmcnt(12)
    v_mfma_f32_32x32x16_bf16 v[80:95], v[220:223], v[140:143], v[80:95]
    ds_read_b64_tr_b16 v[192:193], v12 offset:0
    ds_read_b64_tr_b16 v[194:195], v12 offset:384
    buffer_load_dwordx4 v[164:167], v2, s[16:19], s65 offen offset:1024
    s_waitcnt lgkmcnt(12)
    v_mfma_f32_32x32x16_bf16 v[96:111], v[224:227], v[140:143], v[96:111]
    ds_read_b64_tr_b16 v[196:197], v12 offset:32
    ds_read_b64_tr_b16 v[198:199], v12 offset:416
    s_waitcnt lgkmcnt(12)
    v_mfma_f32_32x32x16_bf16 v[112:127], v[228:231], v[140:143], v[112:127]
    ds_read_b64_tr_b16 v[200:201], v12 offset:64
    ds_read_b64_tr_b16 v[202:203], v12 offset:448
    s_waitcnt vmcnt(6)
    s_waitcnt lgkmcnt(12)
    v_mfma_f32_32x32x16_bf16 v[16:31], v[176:179], v[144:147], v[16:31]
    ds_read_b64_tr_b16 v[204:205], v8 offset:4096
    ds_read_b64_tr_b16 v[206:207], v8 offset:5120
    s_waitcnt lgkmcnt(12)
    v_mfma_f32_32x32x16_bf16 v[32:47], v[180:183], v[144:147], v[32:47]
    ds_read_b64_tr_b16 v[208:209], v9 offset:4096
    ds_read_b64_tr_b16 v[210:211], v9 offset:5120
    buffer_load_dwordx4 v[168:171], v2, s[16:19], s65 offen offset:2048
    s_waitcnt lgkmcnt(12)
    v_mfma_f32_32x32x16_bf16 v[48:63], v[184:187], v[144:147], v[48:63]
    ds_read_b64_tr_b16 v[212:213], v10 offset:4096
    ds_read_b64_tr_b16 v[214:215], v10 offset:5120
    s_waitcnt lgkmcnt(12)
    v_mfma_f32_32x32x16_bf16 v[64:79], v[188:191], v[144:147], v[64:79]
    ds_read_b64_tr_b16 v[216:217], v11 offset:4096
    ds_read_b64_tr_b16 v[218:219], v11 offset:5120
    s_waitcnt lgkmcnt(12)
    v_mfma_f32_32x32x16_bf16 v[80:95], v[192:195], v[144:147], v[80:95]
    ds_read_b64_tr_b16 v[220:221], v12 offset:1536
    ds_read_b64_tr_b16 v[222:223], v12 offset:1920
    buffer_load_dwordx4 v[172:175], v2, s[16:19], s65 offen offset:3072
    s_waitcnt lgkmcnt(12)
    v_mfma_f32_32x32x16_bf16 v[96:111], v[196:199], v[144:147], v[96:111]
    ds_read_b64_tr_b16 v[224:225], v12 offset:1568
    ds_read_b64_tr_b16 v[226:227], v12 offset:1952
    s_waitcnt lgkmcnt(12)
    v_mfma_f32_32x32x16_bf16 v[112:127], v[200:203], v[144:147], v[112:127]
    ds_read_b64_tr_b16 v[228:229], v12 offset:1600
    ds_read_b64_tr_b16 v[230:231], v12 offset:1984
    s_waitcnt lgkmcnt(12)
    v_mfma_f32_32x32x16_bf16 v[16:31], v[204:207], v[148:151], v[16:31]
    ds_read_b64_tr_b16 v[176:177], v8 offset:8192
    ds_read_b64_tr_b16 v[178:179], v8 offset:9216
    s_waitcnt lgkmcnt(12)
    v_mfma_f32_32x32x16_bf16 v[32:47], v[208:211], v[148:151], v[32:47]
    ds_read_b64_tr_b16 v[180:181], v9 offset:8192
    ds_read_b64_tr_b16 v[182:183], v9 offset:9216
    s_add_u32 s92, s90, 7
    s_and_b32 s92, s92, 7
    s_lshl_b32 s93, s92, 19
    s_add_u32 s93, s93, s54
    s_add_u32 m0, s53, 65536
    s_add_u32 s61, s93, 0
    buffer_load_dwordx4 v3, s[20:23], s61 offen lds
    s_waitcnt lgkmcnt(12)
    v_mfma_f32_32x32x16_bf16 v[48:63], v[212:215], v[148:151], v[48:63]
    ds_read_b64_tr_b16 v[184:185], v10 offset:8192
    ds_read_b64_tr_b16 v[186:187], v10 offset:9216
    s_waitcnt lgkmcnt(12)
    v_mfma_f32_32x32x16_bf16 v[64:79], v[216:219], v[148:151], v[64:79]
    ds_read_b64_tr_b16 v[188:189], v11 offset:8192
    ds_read_b64_tr_b16 v[190:191], v11 offset:9216
    s_waitcnt lgkmcnt(12)
    v_mfma_f32_32x32x16_bf16 v[80:95], v[220:223], v[148:151], v[80:95]
    ds_read_b64_tr_b16 v[192:193], v12 offset:3072
    ds_read_b64_tr_b16 v[194:195], v12 offset:3456
    s_add_u32 m0, s53, 66560
    s_add_u32 s61, s93, 32768
    buffer_load_dwordx4 v3, s[20:23], s61 offen lds
    s_waitcnt lgkmcnt(12)
    v_mfma_f32_32x32x16_bf16 v[96:111], v[224:227], v[148:151], v[96:111]
    ds_read_b64_tr_b16 v[196:197], v12 offset:3104
    ds_read_b64_tr_b16 v[198:199], v12 offset:3488
    s_waitcnt lgkmcnt(12)
    v_mfma_f32_32x32x16_bf16 v[112:127], v[228:231], v[148:151], v[112:127]
    ds_read_b64_tr_b16 v[200:201], v12 offset:3136
    ds_read_b64_tr_b16 v[202:203], v12 offset:3520
    s_waitcnt lgkmcnt(12)
    v_mfma_f32_32x32x16_bf16 v[16:31], v[176:179], v[152:155], v[16:31]
    ds_read_b64_tr_b16 v[204:205], v8 offset:12288
    ds_read_b64_tr_b16 v[206:207], v8 offset:13312
    s_waitcnt lgkmcnt(12)
    v_mfma_f32_32x32x16_bf16 v[32:47], v[180:183], v[152:155], v[32:47]
    ds_read_b64_tr_b16 v[208:209], v9 offset:12288
    ds_read_b64_tr_b16 v[210:211], v9 offset:13312
    s_mov_b32 exec_hi, 0xffff
    s_add_u32 m0, s55, 81920
    s_mul_i32 s61, s92, 176128
    s_add_u32 s61, s61, s56
    buffer_load_dwordx4 v4, s[24:27], s61 offen lds
    s_mov_b32 exec_hi, -1
    s_waitcnt lgkmcnt(12)
    v_mfma_f32_32x32x16_bf16 v[48:63], v[184:187], v[152:155], v[48:63]
    ds_read_b64_tr_b16 v[212:213], v10 offset:12288
    ds_read_b64_tr_b16 v[214:215], v10 offset:13312
    s_waitcnt lgkmcnt(12)
    v_mfma_f32_32x32x16_bf16 v[64:79], v[188:191], v[152:155], v[64:79]
    ds_read_b64_tr_b16 v[216:217], v11 offset:12288
    ds_read_b64_tr_b16 v[218:219], v11 offset:13312
    s_waitcnt lgkmcnt(12)
    v_mfma_f32_32x32x16_bf16 v[80:95], v[192:195], v[152:155], v[80:95]
    ds_read_b64_tr_b16 v[220:221], v12 offset:4608
    ds_read_b64_tr_b16 v[222:223], v12 offset:4992
    s_mov_b32 exec_hi, 0xffff
    s_add_u32 m0, s55, 88192
    s_mul_i32 s61, s92, 176128
    s_add_u32 s61, s61, s56
    buffer_load_dwordx4 v4, s[28:31], s61 offen lds
    s_mov_b32 exec_hi, -1
    s_waitcnt lgkmcnt(12)
    v_mfma_f32_32x32x16_bf16 v[96:111], v[196:199], v[152:155], v[96:111]
    ds_read_b64_tr_b16 v[224:225], v12 offset:4640
    ds_read_b64_tr_b16 v[226:227], v12 offset:5024
    s_waitcnt lgkmcnt(12)
    v_mfma_f32_32x32x16_bf16 v[112:127], v[200:203], v[152:155], v[112:127]
    ds_read_b64_tr_b16 v[228:229], v12 offset:4672
    ds_read_b64_tr_b16 v[230:231], v12 offset:5056
    s_barrier
    v_add_u32 v8, 4294836224, v8
    v_add_u32 v9, 4294836224, v9
    v_add_u32 v10, 4294836224, v10
    v_add_u32 v11, 4294836224, v11
    v_add_u32 v12, 4294836224, v12
    s_waitcnt lgkmcnt(12)
    v_mfma_f32_32x32x16_bf16 v[16:31], v[204:207], v[156:159], v[16:31]
    ds_read_b64_tr_b16 v[176:177], v8 offset:0
    ds_read_b64_tr_b16 v[178:179], v8 offset:1024
    s_waitcnt lgkmcnt(12)
    v_mfma_f32_32x32x16_bf16 v[32:47], v[208:211], v[156:159], v[32:47]
    ds_read_b64_tr_b16 v[180:181], v9 offset:0
    ds_read_b64_tr_b16 v[182:183], v9 offset:1024
    s_add_u32 s65, s90, 6
    s_and_b32 s65, s65, 7
    s_lshl_b32 s65, s65, 12
    buffer_load_dwordx4 v[128:131], v2, s[16:19], s65 offen offset:0
    s_waitcnt lgkmcnt(12)
    v_mfma_f32_32x32x16_bf16 v[48:63], v[212:215], v[156:159], v[48:63]
    ds_read_b64_tr_b16 v[184:185], v10 offset:0
    ds_read_b64_tr_b16 v[186:187], v10 offset:1024
    s_waitcnt lgkmcnt(12)
    v_mfma_f32_32x32x16_bf16 v[64:79], v[216:219], v[156:159], v[64:79]
    ds_read_b64_tr_b16 v[188:189], v11 offset:0
    ds_read_b64_tr_b16 v[190:191], v11 offset:1024
    s_waitcnt lgkmcnt(12)
    v_mfma_f32_32x32x16_bf16 v[80:95], v[220:223], v[156:159], v[80:95]
    ds_read_b64_tr_b16 v[192:193], v12 offset:0
    ds_read_b64_tr_b16 v[194:195], v12 offset:384
    buffer_load_dwordx4 v[132:135], v2, s[16:19], s65 offen offset:1024
    s_waitcnt lgkmcnt(12)
    v_mfma_f32_32x32x16_bf16 v[96:111], v[224:227], v[156:159], v[96:111]
    ds_read_b64_tr_b16 v[196:197], v12 offset:32
    ds_read_b64_tr_b16 v[198:199], v12 offset:416
    s_waitcnt lgkmcnt(12)
    v_mfma_f32_32x32x16_bf16 v[112:127], v[228:231], v[156:159], v[112:127]
    ds_read_b64_tr_b16 v[200:201], v12 offset:64
    ds_read_b64_tr_b16 v[202:203], v12 offset:448
    s_waitcnt vmcnt(6)
    s_waitcnt lgkmcnt(12)
    v_mfma_f32_32x32x16_bf16 v[16:31], v[176:179], v[160:163], v[16:31]
    ds_read_b64_tr_b16 v[204:205], v8 offset:4096
    ds_read_b64_tr_b16 v[206:207], v8 offset:5120
    s_waitcnt lgkmcnt(12)
    v_mfma_f32_32x32x16_bf16 v[32:47], v[180:183], v[160:163], v[32:47]
    ds_read_b64_tr_b16 v[208:209], v9 offset:4096
    ds_read_b64_tr_b16 v[210:211], v9 offset:5120
    buffer_load_dwordx4 v[136:139], v2, s[16:19], s65 offen offset:2048
    s_waitcnt lgkmcnt(12)
    v_mfma_f32_32x32x16_bf16 v[48:63], v[184:187], v[160:163], v[48:63]
    ds_read_b64_tr_b16 v[212:213], v10 offset:4096
    ds_read_b64_tr_b16 v[214:215], v10 offset:5120
    s_waitcnt lgkmcnt(12)
    v_mfma_f32_32x32x16_bf16 v[64:79], v[188:191], v[160:163], v[64:79]
    ds_read_b64_tr_b16 v[216:217], v11 offset:4096
    ds_read_b64_tr_b16 v[218:219], v11 offset:5120
    s_waitcnt lgkmcnt(12)
    v_mfma_f32_32x32x16_bf16 v[80:95], v[192:195], v[160:163], v[80:95]
    ds_read_b64_tr_b16 v[220:221], v12 offset:1536
    ds_read_b64_tr_b16 v[222:223], v12 offset:1920
    buffer_load_dwordx4 v[140:143], v2, s[16:19], s65 offen offset:3072
    s_waitcnt lgkmcnt(12)
    v_mfma_f32_32x32x16_bf16 v[96:111], v[196:199], v[160:163], v[96:111]
    ds_read_b64_tr_b16 v[224:225], v12 offset:1568
    ds_read_b64_tr_b16 v[226:227], v12 offset:1952
    s_waitcnt lgkmcnt(12)
    v_mfma_f32_32x32x16_bf16 v[112:127], v[200:203], v[160:163], v[112:127]
    ds_read_b64_tr_b16 v[228:229], v12 offset:1600
    ds_read_b64_tr_b16 v[230:231], v12 offset:1984
    s_waitcnt lgkmcnt(12)
    v_mfma_f32_32x32x16_bf16 v[16:31], v[204:207], v[164:167], v[16:31]
    ds_read_b64_tr_b16 v[176:177], v8 offset:8192
    ds_read_b64_tr_b16 v[178:179], v8 offset:9216
    s_waitcnt lgkmcnt(12)
    v_mfma_f32_32x32x16_bf16 v[32:47], v[208:211], v[164:167], v[32:47]
    ds_read_b64_tr_b16 v[180:181], v9 offset:8192
    ds_read_b64_tr_b16 v[182:183], v9 offset:9216
    s_add_u32 s92, s91, 0
    s_and_b32 s92, s92, 7
    s_lshl_b32 s92, s92, 14
    s_add_u32 s92, s92, s52
    s_add_u32 m0, s52, 98304
    s_add_u32 s61, s92, 0
    buffer_load_dwordx4 v5, s[32:35], s61 offen lds
    s_waitcnt lgkmcnt(12)
    v_mfma_f32_32x32x16_bf16 v[48:63], v[212:215], v[164:167], v[48:63]
    ds_read_b64_tr_b16 v[184:185], v10 offset:8192
    ds_read_b64_tr_b16 v[186:187], v10 offset:9216
    s_waitcnt lgkmcnt(12)
    v_mfma_f32_32x32x16_bf16 v[64:79], v[216:219], v[164:167], v[64:79]
    ds_read_b64_tr_b16 v[188:189], v11 offset:8192
    ds_read_b64_tr_b16 v[190:191], v11 offset:9216
    s_waitcnt lgkmcnt(12)
    v_mfma_f32_32x32x16_bf16 v[80:95], v[220:223], v[164:167], v[80:95]
    ds_read_b64_tr_b16 v[192:193], v12 offset:3072
    ds_read_b64_tr_b16 v[194:195], v12 offset:3456
    s_add_u32 m0, s52, 106496
    s_add_u32 s61, s92, 8192
    buffer_load_dwordx4 v5, s[32:35], s61 offen lds
    s_waitcnt lgkmcnt(12)
    v_mfma_f32_32x32x16_bf16 v[96:111], v[224:227], v[164:167], v[96:111]
    ds_read_b64_tr_b16 v[196:197], v12 offset:3104
    ds_read_b64_tr_b16 v[198:199], v12 offset:3488
    s_waitcnt lgkmcnt(12)
    v_mfma_f32_32x32x16_bf16 v[112:127], v[228:231], v[164:167], v[112:127]
    ds_read_b64_tr_b16 v[200:201], v12 offset:3136
    ds_read_b64_tr_b16 v[202:203], v12 offset:3520
    s_waitcnt lgkmcnt(12)
    v_mfma_f32_32x32x16_bf16 v[16:31], v[176:179], v[168:171], v[16:31]
    ds_read_b64_tr_b16 v[204:205], v8 offset:12288
    ds_read_b64_tr_b16 v[206:207], v8 offset:13312
    s_waitcnt lgkmcnt(12)
    v_mfma_f32_32x32x16_bf16 v[32:47], v[180:183], v[168:171], v[32:47]
    ds_read_b64_tr_b16 v[208:209], v9 offset:12288
    ds_read_b64_tr_b16 v[210:211], v9 offset:13312
    s_add_u32 m0, s52, 114688
    s_add_u32 s61, s92, 0
    buffer_load_dwordx4 v6, s[36:39], s61 offen lds
    s_waitcnt lgkmcnt(12)
    v_mfma_f32_32x32x16_bf16 v[48:63], v[184:187], v[168:171], v[48:63]
    ds_read_b64_tr_b16 v[212:213], v10 offset:12288
    ds_read_b64_tr_b16 v[214:215], v10 offset:13312
    s_waitcnt lgkmcnt(12)
    v_mfma_f32_32x32x16_bf16 v[64:79], v[188:191], v[168:171], v[64:79]
    ds_read_b64_tr_b16 v[216:217], v11 offset:12288
    ds_read_b64_tr_b16 v[218:219], v11 offset:13312
    s_waitcnt lgkmcnt(12)
    v_mfma_f32_32x32x16_bf16 v[80:95], v[192:195], v[168:171], v[80:95]
    ds_read_b64_tr_b16 v[220:221], v12 offset:4608
    ds_read_b64_tr_b16 v[222:223], v12 offset:4992
    s_add_u32 m0, s52, 122880
    s_add_u32 s61, s92, 8192
    buffer_load_dwordx4 v6, s[36:39], s61 offen lds
    s_waitcnt lgkmcnt(12)
    v_mfma_f32_32x32x16_bf16 v[96:111], v[196:199], v[168:171], v[96:111]
    ds_read_b64_tr_b16 v[224:225], v12 offset:4640
    ds_read_b64_tr_b16 v[226:227], v12 offset:5024
    s_waitcnt lgkmcnt(12)
    v_mfma_f32_32x32x16_bf16 v[112:127], v[200:203], v[168:171], v[112:127]
    ds_read_b64_tr_b16 v[228:229], v12 offset:4672
    ds_read_b64_tr_b16 v[230:231], v12 offset:5056
    s_barrier
    v_add_u32 v8, 32768, v8
    v_add_u32 v9, 32768, v9
    v_add_u32 v10, 32768, v10
    v_add_u32 v11, 32768, v11
    v_add_u32 v12, 32768, v12
    s_waitcnt lgkmcnt(12)
    v_mfma_f32_32x32x16_bf16 v[16:31], v[204:207], v[172:175], v[16:31]
    ds_read_b64_tr_b16 v[176:177], v8 offset:0
    ds_read_b64_tr_b16 v[178:179], v8 offset:1024
    s_waitcnt lgkmcnt(12)
    v_mfma_f32_32x32x16_bf16 v[32:47], v[208:211], v[172:175], v[32:47]
    ds_read_b64_tr_b16 v[180:181], v9 offset:0
    ds_read_b64_tr_b16 v[182:183], v9 offset:1024
    s_add_u32 s65, s90, 7
    s_and_b32 s65, s65, 7
    s_lshl_b32 s65, s65, 12
    buffer_load_dwordx4 v[144:147], v2, s[16:19], s65 offen offset:0
    s_waitcnt lgkmcnt(12)
    v_mfma_f32_32x32x16_bf16 v[48:63], v[212:215], v[172:175], v[48:63]
    ds_read_b64_tr_b16 v[184:185], v10 offset:0
    ds_read_b64_tr_b16 v[186:187], v10 offset:1024
    s_waitcnt lgkmcnt(12)
    v_mfma_f32_32x32x16_bf16 v[64:79], v[216:219], v[172:175], v[64:79]
    ds_read_b64_tr_b16 v[188:189], v11 offset:0
    ds_read_b64_tr_b16 v[190:191], v11 offset:1024
    s_waitcnt lgkmcnt(12)
    v_mfma_f32_32x32x16_bf16 v[80:95], v[220:223], v[172:175], v[80:95]
    ds_read_b64_tr_b16 v[192:193], v12 offset:0
    ds_read_b64_tr_b16 v[194:195], v12 offset:384
    buffer_load_dwordx4 v[148:151], v2, s[16:19], s65 offen offset:1024
    s_waitcnt lgkmcnt(12)
    v_mfma_f32_32x32x16_bf16 v[96:111], v[224:227], v[172:175], v[96:111]
    ds_read_b64_tr_b16 v[196:197], v12 offset:32
    ds_read_b64_tr_b16 v[198:199], v12 offset:416
    s_waitcnt lgkmcnt(12)
    v_mfma_f32_32x32x16_bf16 v[112:127], v[228:231], v[172:175], v[112:127]
    ds_read_b64_tr_b16 v[200:201], v12 offset:64
    ds_read_b64_tr_b16 v[202:203], v12 offset:448
    s_waitcnt vmcnt(6)
    s_waitcnt lgkmcnt(12)
    v_mfma_f32_32x32x16_bf16 v[16:31], v[176:179], v[128:131], v[16:31]
    ds_read_b64_tr_b16 v[204:205], v8 offset:4096
    ds_read_b64_tr_b16 v[206:207], v8 offset:5120
    s_waitcnt lgkmcnt(12)
    v_mfma_f32_32x32x16_bf16 v[32:47], v[180:183], v[128:131], v[32:47]
    ds_read_b64_tr_b16 v[208:209], v9 offset:4096
    ds_read_b64_tr_b16 v[210:211], v9 offset:5120
    buffer_load_dwordx4 v[152:155], v2, s[16:19], s65 offen offset:2048
    s_waitcnt lgkmcnt(12)
    v_mfma_f32_32x32x16_bf16 v[48:63], v[184:187], v[128:131], v[48:63]
    ds_read_b64_tr_b16 v[212:213], v10 offset:4096
    ds_read_b64_tr_b16 v[214:215], v10 offset:5120
    s_waitcnt lgkmcnt(12)
    v_mfma_f32_32x32x16_bf16 v[64:79], v[188:191], v[128:131], v[64:79]
    ds_read_b64_tr_b16 v[216:217], v11 offset:4096
    ds_read_b64_tr_b16 v[218:219], v11 offset:5120
    s_waitcnt lgkmcnt(12)
    v_mfma_f32_32x32x16_bf16 v[80:95], v[192:195], v[128:131], v[80:95]
    ds_read_b64_tr_b16 v[220:221], v12 offset:1536
    ds_read_b64_tr_b16 v[222:223], v12 offset:1920
    buffer_load_dwordx4 v[156:159], v2, s[16:19], s65 offen offset:3072
    s_waitcnt lgkmcnt(12)
    v_mfma_f32_32x32x16_bf16 v[96:111], v[196:199], v[128:131], v[96:111]
    ds_read_b64_tr_b16 v[224:225], v12 offset:1568
    ds_read_b64_tr_b16 v[226:227], v12 offset:1952
    s_waitcnt lgkmcnt(12)
    v_mfma_f32_32x32x16_bf16 v[112:127], v[200:203], v[128:131], v[112:127]
    ds_read_b64_tr_b16 v[228:229], v12 offset:1600
    ds_read_b64_tr_b16 v[230:231], v12 offset:1984
    s_waitcnt lgkmcnt(12)
    v_mfma_f32_32x32x16_bf16 v[16:31], v[204:207], v[132:135], v[16:31]
    ds_read_b64_tr_b16 v[176:177], v8 offset:8192
    ds_read_b64_tr_b16 v[178:179], v8 offset:9216
    s_waitcnt lgkmcnt(12)
    v_mfma_f32_32x32x16_bf16 v[32:47], v[208:211], v[132:135], v[32:47]
    ds_read_b64_tr_b16 v[180:181], v9 offset:8192
    ds_read_b64_tr_b16 v[182:183], v9 offset:9216
    s_add_u32 s92, s91, 1
    s_and_b32 s92, s92, 7
    s_lshl_b32 s92, s92, 14
    s_add_u32 s92, s92, s52
    s_add_u32 m0, s52, 131072
    s_add_u32 s61, s92, 0
    buffer_load_dwordx4 v5, s[32:35], s61 offen lds
    s_waitcnt lgkmcnt(12)
    v_mfma_f32_32x32x16_bf16 v[48:63], v[212:215], v[132:135], v[48:63]
    ds_read_b64_tr_b16 v[184:185], v10 offset:8192
    ds_read_b64_tr_b16 v[186:187], v10 offset:9216
    s_waitcnt lgkmcnt(12)
    v_mfma_f32_32x32x16_bf16 v[64:79], v[216:219], v[132:135], v[64:79]
    ds_read_b64_tr_b16 v[188:189], v11 offset:8192
    ds_read_b64_tr_b16 v[190:191], v11 offset:9216
    s_waitcnt lgkmcnt(12)
    v_mfma_f32_32x32x16_bf16 v[80:95], v[220:223], v[132:135], v[80:95]
    ds_read_b64_tr_b16 v[192:193], v12 offset:3072
    ds_read_b64_tr_b16 v[194:195], v12 offset:3456
    s_add_u32 m0, s52, 139264
    s_add_u32 s61, s92, 8192
    buffer_load_dwordx4 v5, s[32:35], s61 offen lds
    s_waitcnt lgkmcnt(12)
    v_mfma_f32_32x32x16_bf16 v[96:111], v[224:227], v[132:135], v[96:111]
    ds_read_b64_tr_b16 v[196:197], v12 offset:3104
    ds_read_b64_tr_b16 v[198:199], v12 offset:3488
    s_waitcnt lgkmcnt(12)
    v_mfma_f32_32x32x16_bf16 v[112:127], v[228:231], v[132:135], v[112:127]
    ds_read_b64_tr_b16 v[200:201], v12 offset:3136
    ds_read_b64_tr_b16 v[202:203], v12 offset:3520
    s_waitcnt lgkmcnt(12)
    v_mfma_f32_32x32x16_bf16 v[16:31], v[176:179], v[136:139], v[16:31]
    ds_read_b64_tr_b16 v[204:205], v8 offset:12288
    ds_read_b64_tr_b16 v[206:207], v8 offset:13312
    s_waitcnt lgkmcnt(12)
    v_mfma_f32_32x32x16_bf16 v[32:47], v[180:183], v[136:139], v[32:47]
    ds_read_b64_tr_b16 v[208:209], v9 offset:12288
    ds_read_b64_tr_b16 v[210:211], v9 offset:13312
    s_add_u32 m0, s52, 147456
    s_add_u32 s61, s92, 0
    buffer_load_dwordx4 v6, s[36:39], s61 offen lds
    s_waitcnt lgkmcnt(12)
    v_mfma_f32_32x32x16_bf16 v[48:63], v[184:187], v[136:139], v[48:63]
    ds_read_b64_tr_b16 v[212:213], v10 offset:12288
    ds_read_b64_tr_b16 v[214:215], v10 offset:13312
    s_waitcnt lgkmcnt(12)
    v_mfma_f32_32x32x16_bf16 v[64:79], v[188:191], v[136:139], v[64:79]
    ds_read_b64_tr_b16 v[216:217], v11 offset:12288
    ds_read_b64_tr_b16 v[218:219], v11 offset:13312
    s_waitcnt lgkmcnt(12)
    v_mfma_f32_32x32x16_bf16 v[80:95], v[192:195], v[136:139], v[80:95]
    ds_read_b64_tr_b16 v[220:221], v12 offset:4608
    ds_read_b64_tr_b16 v[222:223], v12 offset:4992
    s_add_u32 m0, s52, 155648
    s_add_u32 s61, s92, 8192
    buffer_load_dwordx4 v6, s[36:39], s61 offen lds
    s_waitcnt lgkmcnt(12)
    v_mfma_f32_32x32x16_bf16 v[96:111], v[196:199], v[136:139], v[96:111]
    ds_read_b64_tr_b16 v[224:225], v12 offset:4640
    ds_read_b64_tr_b16 v[226:227], v12 offset:5024
    s_waitcnt lgkmcnt(12)
    v_mfma_f32_32x32x16_bf16 v[112:127], v[200:203], v[136:139], v[112:127]
    ds_read_b64_tr_b16 v[228:229], v12 offset:4672
    ds_read_b64_tr_b16 v[230:231], v12 offset:5056
    s_barrier
    v_add_u32 v8, 32768, v8
    v_add_u32 v9, 32768, v9
    v_add_u32 v10, 32768, v10
    v_add_u32 v11, 32768, v11
    v_add_u32 v12, 32768, v12
    s_waitcnt lgkmcnt(12)
    v_mfma_f32_32x32x16_bf16 v[16:31], v[204:207], v[140:143], v[16:31]
    ds_read_b64_tr_b16 v[176:177], v8 offset:0
    ds_read_b64_tr_b16 v[178:179], v8 offset:1024
    s_waitcnt lgkmcnt(12)
    v_mfma_f32_32x32x16_bf16 v[32:47], v[208:211], v[140:143], v[32:47]
    ds_read_b64_tr_b16 v[180:181], v9 offset:0
    ds_read_b64_tr_b16 v[182:183], v9 offset:1024
    s_add_u32 s92, s91, 2
    s_and_b32 s92, s92, 7
    s_lshl_b32 s92, s92, 14
    s_add_u32 s92, s92, s52
    s_add_u32 m0, s52, 0
    s_add_u32 s61, s92, 0
    buffer_load_dwordx4 v5, s[32:35], s61 offen lds
    s_waitcnt lgkmcnt(12)
    v_mfma_f32_32x32x16_bf16 v[48:63], v[212:215], v[140:143], v[48:63]
    ds_read_b64_tr_b16 v[184:185], v10 offset:0
    ds_read_b64_tr_b16 v[186:187], v10 offset:1024
    s_waitcnt lgkmcnt(12)
    v_mfma_f32_32x32x16_bf16 v[64:79], v[216:219], v[140:143], v[64:79]
    ds_read_b64_tr_b16 v[188:189], v11 offset:0
    ds_read_b64_tr_b16 v[190:191], v11 offset:1024
    s_waitcnt lgkmcnt(12)
    v_mfma_f32_32x32x16_bf16 v[80:95], v[220:223], v[140:143], v[80:95]
    ds_read_b64_tr_b16 v[192:193], v12 offset:0
    ds_read_b64_tr_b16 v[194:195], v12 offset:384
    s_add_u32 m0, s52, 8192
    s_add_u32 s61, s92, 8192
    buffer_load_dwordx4 v5, s[32:35], s61 offen lds
    s_waitcnt lgkmcnt(12)
    v_mfma_f32_32x32x16_bf16 v[96:111], v[224:227], v[140:143], v[96:111]
    ds_read_b64_tr_b16 v[196:197], v12 offset:32
    ds_read_b64_tr_b16 v[198:199], v12 offset:416
    s_waitcnt lgkmcnt(12)
    v_mfma_f32_32x32x16_bf16 v[112:127], v[228:231], v[140:143], v[112:127]
    ds_read_b64_tr_b16 v[200:201], v12 offset:64
    ds_read_b64_tr_b16 v[202:203], v12 offset:448
    s_waitcnt vmcnt(6)
    s_waitcnt lgkmcnt(12)
    v_mfma_f32_32x32x16_bf16 v[16:31], v[176:179], v[144:147], v[16:31]
    ds_read_b64_tr_b16 v[204:205], v8 offset:4096
    ds_read_b64_tr_b16 v[206:207], v8 offset:5120
    s_waitcnt lgkmcnt(12)
    v_mfma_f32_32x32x16_bf16 v[32:47], v[180:183], v[144:147], v[32:47]
    ds_read_b64_tr_b16 v[208:209], v9 offset:4096
    ds_read_b64_tr_b16 v[210:211], v9 offset:5120
    s_add_u32 m0, s52, 16384
    s_add_u32 s61, s92, 0
    buffer_load_dwordx4 v6, s[36:39], s61 offen lds
    s_waitcnt lgkmcnt(12)
    v_mfma_f32_32x32x16_bf16 v[48:63], v[184:187], v[144:147], v[48:63]
    ds_read_b64_tr_b16 v[212:213], v10 offset:4096
    ds_read_b64_tr_b16 v[214:215], v10 offset:5120
    s_waitcnt lgkmcnt(12)
    v_mfma_f32_32x32x16_bf16 v[64:79], v[188:191], v[144:147], v[64:79]
    ds_read_b64_tr_b16 v[216:217], v11 offset:4096
    ds_read_b64_tr_b16 v[218:219], v11 offset:5120
    s_waitcnt lgkmcnt(12)
    v_mfma_f32_32x32x16_bf16 v[80:95], v[192:195], v[144:147], v[80:95]
    ds_read_b64_tr_b16 v[220:221], v12 offset:1536
    ds_read_b64_tr_b16 v[222:223], v12 offset:1920
    s_add_u32 m0, s52, 24576
    s_add_u32 s61, s92, 8192
    buffer_load_dwordx4 v6, s[36:39], s61 offen lds
    s_waitcnt lgkmcnt(12)
    v_mfma_f32_32x32x16_bf16 v[96:111], v[196:199], v[144:147], v[96:111]
    ds_read_b64_tr_b16 v[224:225], v12 offset:1568
    ds_read_b64_tr_b16 v[226:227], v12 offset:1952
    s_waitcnt lgkmcnt(12)
    v_mfma_f32_32x32x16_bf16 v[112:127], v[200:203], v[144:147], v[112:127]
    ds_read_b64_tr_b16 v[228:229], v12 offset:1600
    ds_read_b64_tr_b16 v[230:231], v12 offset:1984
    s_waitcnt lgkmcnt(12)
    v_mfma_f32_32x32x16_bf16 v[16:31], v[204:207], v[148:151], v[16:31]
    ds_read_b64_tr_b16 v[176:177], v8 offset:8192
    ds_read_b64_tr_b16 v[178:179], v8 offset:9216
    s_waitcnt lgkmcnt(12)
    v_mfma_f32_32x32x16_bf16 v[32:47], v[208:211], v[148:151], v[32:47]
    ds_read_b64_tr_b16 v[180:181], v9 offset:8192
    ds_read_b64_tr_b16 v[182:183], v9 offset:9216
    s_waitcnt lgkmcnt(12)
    v_mfma_f32_32x32x16_bf16 v[48:63], v[212:215], v[148:151], v[48:63]
    ds_read_b64_tr_b16 v[184:185], v10 offset:8192
    ds_read_b64_tr_b16 v[186:187], v10 offset:9216
    s_waitcnt lgkmcnt(12)
    v_mfma_f32_32x32x16_bf16 v[64:79], v[216:219], v[148:151], v[64:79]
    ds_read_b64_tr_b16 v[188:189], v11 offset:8192
    ds_read_b64_tr_b16 v[190:191], v11 offset:9216
    s_waitcnt lgkmcnt(12)
    v_mfma_f32_32x32x16_bf16 v[80:95], v[220:223], v[148:151], v[80:95]
    ds_read_b64_tr_b16 v[192:193], v12 offset:3072
    ds_read_b64_tr_b16 v[194:195], v12 offset:3456
    s_waitcnt lgkmcnt(12)
    v_mfma_f32_32x32x16_bf16 v[96:111], v[224:227], v[148:151], v[96:111]
    ds_read_b64_tr_b16 v[196:197], v12 offset:3104
    ds_read_b64_tr_b16 v[198:199], v12 offset:3488
    s_waitcnt lgkmcnt(12)
    v_mfma_f32_32x32x16_bf16 v[112:127], v[228:231], v[148:151], v[112:127]
    ds_read_b64_tr_b16 v[200:201], v12 offset:3136
    ds_read_b64_tr_b16 v[202:203], v12 offset:3520
    s_waitcnt lgkmcnt(12)
    v_mfma_f32_32x32x16_bf16 v[16:31], v[176:179], v[152:155], v[16:31]
    ds_read_b64_tr_b16 v[204:205], v8 offset:12288
    ds_read_b64_tr_b16 v[206:207], v8 offset:13312
    s_waitcnt lgkmcnt(12)
    v_mfma_f32_32x32x16_bf16 v[32:47], v[180:183], v[152:155], v[32:47]
    ds_read_b64_tr_b16 v[208:209], v9 offset:12288
    ds_read_b64_tr_b16 v[210:211], v9 offset:13312
    s_waitcnt lgkmcnt(12)
    v_mfma_f32_32x32x16_bf16 v[48:63], v[184:187], v[152:155], v[48:63]
    ds_read_b64_tr_b16 v[212:213], v10 offset:12288
    ds_read_b64_tr_b16 v[214:215], v10 offset:13312
    s_waitcnt lgkmcnt(12)
    v_mfma_f32_32x32x16_bf16 v[64:79], v[188:191], v[152:155], v[64:79]
    ds_read_b64_tr_b16 v[216:217], v11 offset:12288
    ds_read_b64_tr_b16 v[218:219], v11 offset:13312
    s_waitcnt lgkmcnt(12)
    v_mfma_f32_32x32x16_bf16 v[80:95], v[192:195], v[152:155], v[80:95]
    ds_read_b64_tr_b16 v[220:221], v12 offset:4608
    ds_read_b64_tr_b16 v[222:223], v12 offset:4992
    s_waitcnt lgkmcnt(12)
    v_mfma_f32_32x32x16_bf16 v[96:111], v[196:199], v[152:155], v[96:111]
    ds_read_b64_tr_b16 v[224:225], v12 offset:4640
    ds_read_b64_tr_b16 v[226:227], v12 offset:5024
    s_waitcnt lgkmcnt(12)
    v_mfma_f32_32x32x16_bf16 v[112:127], v[200:203], v[152:155], v[112:127]
    ds_read_b64_tr_b16 v[228:229], v12 offset:4672
    ds_read_b64_tr_b16 v[230:231], v12 offset:5056
    s_barrier
    s_waitcnt lgkmcnt(12)
    v_mfma_f32_32x32x16_bf16 v[16:31], v[204:207], v[156:159], v[16:31]
    s_waitcnt lgkmcnt(10)
    v_mfma_f32_32x32x16_bf16 v[32:47], v[208:211], v[156:159], v[32:47]
    s_add_u32 s92, s91, 3
    s_and_b32 s92, s92, 7
    s_lshl_b32 s92, s92, 14
    s_add_u32 s92, s92, s52
    s_add_u32 m0, s52, 32768
    s_add_u32 s61, s92, 0
    buffer_load_dwordx4 v5, s[32:35], s61 offen lds
    s_waitcnt lgkmcnt(8)
    v_mfma_f32_32x32x16_bf16 v[48:63], v[212:215], v[156:159], v[48:63]
    s_waitcnt lgkmcnt(6)
    v_mfma_f32_32x32x16_bf16 v[64:79], v[216:219], v[156:159], v[64:79]
    s_waitcnt lgkmcnt(4)
    v_mfma_f32_32x32x16_bf16 v[80:95], v[220:223], v[156:159], v[80:95]
    s_add_u32 m0, s52, 40960
    s_add_u32 s61, s92, 8192
    buffer_load_dwordx4 v5, s[32:35], s61 offen lds
    s_waitcnt lgkmcnt(2)
    v_mfma_f32_32x32x16_bf16 v[96:111], v[224:227], v[156:159], v[96:111]
    s_waitcnt lgkmcnt(0)
    v_mfma_f32_32x32x16_bf16 v[112:127], v[228:231], v[156:159], v[112:127]
    v_mul_f32 v16, 0x3e0293ee, v16
    v_mul_f32 v17, 0x3e0293ee, v17
    v_mul_f32 v18, 0x3e0293ee, v18
    v_mul_f32 v19, 0x3e0293ee, v19
    v_mul_f32 v20, 0x3e0293ee, v20
    v_mul_f32 v21, 0x3e0293ee, v21
    v_mul_f32 v22, 0x3e0293ee, v22
    v_mul_f32 v23, 0x3e0293ee, v23
    v_mul_f32 v24, 0x3e0293ee, v24
    v_mul_f32 v25, 0x3e0293ee, v25
    v_mul_f32 v26, 0x3e0293ee, v26
    v_mul_f32 v27, 0x3e0293ee, v27
    v_mul_f32 v28, 0x3e0293ee, v28
    v_mul_f32 v29, 0x3e0293ee, v29
    v_mul_f32 v30, 0x3e0293ee, v30
    v_mul_f32 v31, 0x3e0293ee, v31
    v_mul_f32 v32, 0x3e0293ee, v32
    v_mul_f32 v33, 0x3e0293ee, v33
    v_mul_f32 v34, 0x3e0293ee, v34
    v_mul_f32 v35, 0x3e0293ee, v35
    v_mul_f32 v36, 0x3e0293ee, v36
    v_mul_f32 v37, 0x3e0293ee, v37
    v_mul_f32 v38, 0x3e0293ee, v38
    v_mul_f32 v39, 0x3e0293ee, v39
    v_mul_f32 v40, 0x3e0293ee, v40
    v_mul_f32 v41, 0x3e0293ee, v41
    v_mul_f32 v42, 0x3e0293ee, v42
    v_mul_f32 v43, 0x3e0293ee, v43
    v_mul_f32 v44, 0x3e0293ee, v44
    v_mul_f32 v45, 0x3e0293ee, v45
    v_mul_f32 v46, 0x3e0293ee, v46
    v_mul_f32 v47, 0x3e0293ee, v47
    v_mul_f32 v48, 0x3e0293ee, v48
    v_mul_f32 v49, 0x3e0293ee, v49
    v_mul_f32 v50, 0x3e0293ee, v50
    v_mul_f32 v51, 0x3e0293ee, v51
    v_mul_f32 v52, 0x3e0293ee, v52
    v_mul_f32 v53, 0x3e0293ee, v53
    v_mul_f32 v54, 0x3e0293ee, v54
    v_mul_f32 v55, 0x3e0293ee, v55
    v_mul_f32 v56, 0x3e0293ee, v56
    v_mul_f32 v57, 0x3e0293ee, v57
    v_mul_f32 v58, 0x3e0293ee, v58
    v_mul_f32 v59, 0x3e0293ee, v59
    v_mul_f32 v60, 0x3e0293ee, v60
    v_mul_f32 v61, 0x3e0293ee, v61
    v_mul_f32 v62, 0x3e0293ee, v62
    v_mul_f32 v63, 0x3e0293ee, v63
    v_mul_f32 v64, 0x3e0293ee, v64
    v_mul_f32 v65, 0x3e0293ee, v65
    v_mul_f32 v66, 0x3e0293ee, v66
    v_mul_f32 v67, 0x3e0293ee, v67
    v_mul_f32 v68, 0x3e0293ee, v68
    v_mul_f32 v69, 0x3e0293ee, v69
    v_mul_f32 v70, 0x3e0293ee, v70
    v_mul_f32 v71, 0x3e0293ee, v71
    v_mul_f32 v72, 0x3e0293ee, v72
    v_mul_f32 v73, 0x3e0293ee, v73
    v_mul_f32 v74, 0x3e0293ee, v74
    v_mul_f32 v75, 0x3e0293ee, v75
    v_mul_f32 v76, 0x3e0293ee, v76
    v_mul_f32 v77, 0x3e0293ee, v77
    v_mul_f32 v78, 0x3e0293ee, v78
    v_mul_f32 v79, 0x3e0293ee, v79
    v_cvt_pk_bf16_f32 v224, v16, v17
    v_cvt_pk_bf16_f32 v225, v18, v19
    v_cvt_pk_bf16_f32 v226, v20, v21
    v_cvt_pk_bf16_f32 v227, v22, v23
    v_cvt_pk_bf16_f32 v228, v24, v25
    v_cvt_pk_bf16_f32 v229, v26, v27
    v_cvt_pk_bf16_f32 v230, v28, v29
    v_cvt_pk_bf16_f32 v231, v30, v31
    v_cvt_pk_bf16_f32 v232, v32, v33
    v_cvt_pk_bf16_f32 v233, v34, v35
    v_cvt_pk_bf16_f32 v234, v36, v37
    v_cvt_pk_bf16_f32 v235, v38, v39
    v_cvt_pk_bf16_f32 v236, v40, v41
    v_cvt_pk_bf16_f32 v237, v42, v43
    v_cvt_pk_bf16_f32 v238, v44, v45
    v_cvt_pk_bf16_f32 v239, v46, v47
    v_cvt_pk_bf16_f32 v240, v48, v49
    v_cvt_pk_bf16_f32 v241, v50, v51
    v_cvt_pk_bf16_f32 v242, v52, v53
    v_cvt_pk_bf16_f32 v243, v54, v55
    v_cvt_pk_bf16_f32 v244, v56, v57
    v_cvt_pk_bf16_f32 v245, v58, v59
    v_cvt_pk_bf16_f32 v246, v60, v61
    v_cvt_pk_bf16_f32 v247, v62, v63
    v_cvt_pk_bf16_f32 v248, v64, v65
    v_cvt_pk_bf16_f32 v249, v66, v67
    v_cvt_pk_bf16_f32 v250, v68, v69
    v_cvt_pk_bf16_f32 v251, v70, v71
    v_cvt_pk_bf16_f32 v252, v72, v73
    v_cvt_pk_bf16_f32 v253, v74, v75
    v_cvt_pk_bf16_f32 v254, v76, v77
    v_cvt_pk_bf16_f32 v255, v78, v79
    v_lshrrev_b32 v15, 5, v1
    v_and_b32 v7, 15, v1
    v_and_b32 v13, 31, v1
    v_lshlrev_b32 v13, 8, v13
    v_add_u32 v13, 98304, v13
    v_add_u32 v14, 0, v15
    v_xor_b32 v14, v14, v7
    v_lshl_add_u32 v208, v14, 4, v13
    v_add_u32 v14, 2, v15
    v_xor_b32 v14, v14, v7
    v_lshl_add_u32 v209, v14, 4, v13
    v_add_u32 v14, 4, v15
    v_xor_b32 v14, v14, v7
    v_lshl_add_u32 v210, v14, 4, v13
    v_add_u32 v14, 6, v15
    v_xor_b32 v14, v14, v7
    v_lshl_add_u32 v211, v14, 4, v13
    v_add_u32 v14, 8, v15
    v_xor_b32 v14, v14, v7
    v_lshl_add_u32 v212, v14, 4, v13
    v_add_u32 v14, 10, v15
    v_xor_b32 v14, v14, v7
    v_lshl_add_u32 v213, v14, 4, v13
    v_add_u32 v14, 12, v15
    v_xor_b32 v14, v14, v7
    v_lshl_add_u32 v214, v14, 4, v13
    v_add_u32 v14, 14, v15
    v_xor_b32 v14, v14, v7
    v_lshl_add_u32 v215, v14, 4, v13
    ds_read_b128 v[128:131], v208 offset:0
    ds_read_b128 v[132:135], v209 offset:0
    ds_read_b128 v[136:139], v210 offset:0
    ds_read_b128 v[140:143], v211 offset:0
    ds_read_b128 v[144:147], v212 offset:0
    ds_read_b128 v[148:151], v213 offset:0
    ds_read_b128 v[152:155], v214 offset:0
    ds_read_b128 v[156:159], v215 offset:0
    s_mul_i32 s57, s48, 90112
    v_lshl_add_u32 v15, v1, 4, s57
    s_mov_b32 s62, 0x3d372713
    s_mov_b32 s63, 0xc0135761
    v_mul_f32 v160, v80, v80
    v_mul_f32 v161, v81, v81
    v_mul_f32 v162, v82, v82
    v_mul_f32 v163, v83, v83
    v_mul_f32 v164, v84, v84
    v_mul_f32 v165, v85, v85
    v_mul_f32 v166, v86, v86
    v_mul_f32 v167, v87, v87
    v_fma_f32 v160, v160, s62, 1.0
    v_fma_f32 v161, v161, s62, 1.0
    v_fma_f32 v162, v162, s62, 1.0
    v_fma_f32 v163, v163, s62, 1.0
    v_fma_f32 v164, v164, s62, 1.0
    v_fma_f32 v165, v165, s62, 1.0
    v_fma_f32 v166, v166, s62, 1.0
    v_fma_f32 v167, v167, s62, 1.0
    v_mul_f32 v160, v160, v80
    v_mul_f32 v161, v161, v81
    v_mul_f32 v162, v162, v82
    v_mul_f32 v163, v163, v83
    v_mul_f32 v164, v164, v84
    v_mul_f32 v165, v165, v85
    v_mul_f32 v166, v166, v86
    v_mul_f32 v167, v167, v87
    v_mul_f32 v160, s63, v160
    v_mul_f32 v161, s63, v161
    v_mul_f32 v162, s63, v162
    v_mul_f32 v163, s63, v163
    v_mul_f32 v164, s63, v164
    v_mul_f32 v165, s63, v165
    v_mul_f32 v166, s63, v166
    v_mul_f32 v167, s63, v167
    v_exp_f32 v160, v160
    v_exp_f32 v161, v161
    v_exp_f32 v162, v162
    v_exp_f32 v163, v163
    v_exp_f32 v164, v164
    v_exp_f32 v165, v165
    v_exp_f32 v166, v166
    v_exp_f32 v167, v167
    v_add_f32 v160, 1.0, v160
    v_add_f32 v161, 1.0, v161
    v_add_f32 v162, 1.0, v162
    v_add_f32 v163, 1.0, v163
    v_add_f32 v164, 1.0, v164
    v_add_f32 v165, 1.0, v165
    v_add_f32 v166, 1.0, v166
    v_add_f32 v167, 1.0, v167
    v_rcp_f32 v160, v160
    v_rcp_f32 v161, v161
    v_rcp_f32 v162, v162
    v_rcp_f32 v163, v163
    v_rcp_f32 v164, v164
    v_rcp_f32 v165, v165
    v_rcp_f32 v166, v166
    v_rcp_f32 v167, v167
    v_mul_f32 v160, v160, v80
    v_mul_f32 v161, v161, v81
    v_mul_f32 v162, v162, v82
    v_mul_f32 v163, v163, v83
    v_mul_f32 v164, v164, v84
    v_mul_f32 v165, v165, v85
    v_mul_f32 v166, v166, v86
    v_mul_f32 v167, v167, v87
    v_mul_f32 v160, v160, v88
    v_mul_f32 v161, v161, v89
    v_mul_f32 v162, v162, v90
    v_mul_f32 v163, v163, v91
    v_mul_f32 v164, v164, v92
    v_mul_f32 v165, v165, v93
    v_mul_f32 v166, v166, v94
    v_mul_f32 v167, v167, v95
    v_cvt_pk_bf16_f32 v176, v160, v161
    v_cvt_pk_bf16_f32 v177, v162, v163
    v_cvt_pk_bf16_f32 v178, v164, v165
    v_cvt_pk_bf16_f32 v179, v166, v167
    s_lshl_b32 s61, s49, 10
    s_add_u32 s61, s61, 0
    buffer_store_dwordx4 v[176:179], v15, s[44:47], s61 offen sc1
    v_mul_f32 v160, v96, v96
    v_mul_f32 v161, v97, v97
    v_mul_f32 v162, v98, v98
    v_mul_f32 v163, v99, v99
    v_mul_f32 v164, v100, v100
    v_mul_f32 v165, v101, v101
    v_mul_f32 v166, v102, v102
    v_mul_f32 v167, v103, v103
    v_fma_f32 v160, v160, s62, 1.0
    v_fma_f32 v161, v161, s62, 1.0
    v_fma_f32 v162, v162, s62, 1.0
    v_fma_f32 v163, v163, s62, 1.0
    v_fma_f32 v164, v164, s62, 1.0
    v_fma_f32 v165, v165, s62, 1.0
    v_fma_f32 v166, v166, s62, 1.0
    v_fma_f32 v167, v167, s62, 1.0
    v_mul_f32 v160, v160, v96
    v_mul_f32 v161, v161, v97
    v_mul_f32 v162, v162, v98
    v_mul_f32 v163, v163, v99
    v_mul_f32 v164, v164, v100
    v_mul_f32 v165, v165, v101
    v_mul_f32 v166, v166, v102
    v_mul_f32 v167, v167, v103
    v_mul_f32 v160, s63, v160
    v_mul_f32 v161, s63, v161
    v_mul_f32 v162, s63, v162
    v_mul_f32 v163, s63, v163
    v_mul_f32 v164, s63, v164
    v_mul_f32 v165, s63, v165
    v_mul_f32 v166, s63, v166
    v_mul_f32 v167, s63, v167
    v_exp_f32 v160, v160
    v_exp_f32 v161, v161
    v_exp_f32 v162, v162
    v_exp_f32 v163, v163
    v_exp_f32 v164, v164
    v_exp_f32 v165, v165
    v_exp_f32 v166, v166
    v_exp_f32 v167, v167
    v_add_f32 v160, 1.0, v160
    v_add_f32 v161, 1.0, v161
    v_add_f32 v162, 1.0, v162
    v_add_f32 v163, 1.0, v163
    v_add_f32 v164, 1.0, v164
    v_add_f32 v165, 1.0, v165
    v_add_f32 v166, 1.0, v166
    v_add_f32 v167, 1.0, v167
    v_rcp_f32 v160, v160
    v_rcp_f32 v161, v161
    v_rcp_f32 v162, v162
    v_rcp_f32 v163, v163
    v_rcp_f32 v164, v164
    v_rcp_f32 v165, v165
    v_rcp_f32 v166, v166
    v_rcp_f32 v167, v167
    v_mul_f32 v160, v160, v96
    v_mul_f32 v161, v161, v97
    v_mul_f32 v162, v162, v98
    v_mul_f32 v163, v163, v99
    v_mul_f32 v164, v164, v100
    v_mul_f32 v165, v165, v101
    v_mul_f32 v166, v166, v102
    v_mul_f32 v167, v167, v103
    v_mul_f32 v160, v160, v104
    v_mul_f32 v161, v161, v105
    v_mul_f32 v162, v162, v106
    v_mul_f32 v163, v163, v107
    v_mul_f32 v164, v164, v108
    v_mul_f32 v165, v165, v109
    v_mul_f32 v166, v166, v110
    v_mul_f32 v167, v167, v111
    v_cvt_pk_bf16_f32 v180, v160, v161
    v_cvt_pk_bf16_f32 v181, v162, v163
    v_cvt_pk_bf16_f32 v182, v164, v165
    v_cvt_pk_bf16_f32 v183, v166, v167
    s_lshl_b32 s61, s49, 10
    s_add_u32 s61, s61, 32768
    buffer_store_dwordx4 v[180:183], v15, s[44:47], s61 offen sc1
    v_mul_f32 v160, v112, v112
    v_mul_f32 v161, v113, v113
    v_mul_f32 v162, v114, v114
    v_mul_f32 v163, v115, v115
    v_mul_f32 v164, v116, v116
    v_mul_f32 v165, v117, v117
    v_mul_f32 v166, v118, v118
    v_mul_f32 v167, v119, v119
    v_fma_f32 v160, v160, s62, 1.0
    v_fma_f32 v161, v161, s62, 1.0
    v_fma_f32 v162, v162, s62, 1.0
    v_fma_f32 v163, v163, s62, 1.0
    v_fma_f32 v164, v164, s62, 1.0
    v_fma_f32 v165, v165, s62, 1.0
    v_fma_f32 v166, v166, s62, 1.0
    v_fma_f32 v167, v167, s62, 1.0
    v_mul_f32 v160, v160, v112
    v_mul_f32 v161, v161, v113
    v_mul_f32 v162, v162, v114
    v_mul_f32 v163, v163, v115
    v_mul_f32 v164, v164, v116
    v_mul_f32 v165, v165, v117
    v_mul_f32 v166, v166, v118
    v_mul_f32 v167, v167, v119
    v_mul_f32 v160, s63, v160
    v_mul_f32 v161, s63, v161
    v_mul_f32 v162, s63, v162
    v_mul_f32 v163, s63, v163
    v_mul_f32 v164, s63, v164
    v_mul_f32 v165, s63, v165
    v_mul_f32 v166, s63, v166
    v_mul_f32 v167, s63, v167
    v_exp_f32 v160, v160
    v_exp_f32 v161, v161
    v_exp_f32 v162, v162
    v_exp_f32 v163, v163
    v_exp_f32 v164, v164
    v_exp_f32 v165, v165
    v_exp_f32 v166, v166
    v_exp_f32 v167, v167
    v_add_f32 v160, 1.0, v160
    v_add_f32 v161, 1.0, v161
    v_add_f32 v162, 1.0, v162
    v_add_f32 v163, 1.0, v163
    v_add_f32 v164, 1.0, v164
    v_add_f32 v165, 1.0, v165
    v_add_f32 v166, 1.0, v166
    v_add_f32 v167, 1.0, v167
    v_rcp_f32 v160, v160
    v_rcp_f32 v161, v161
    v_rcp_f32 v162, v162
    v_rcp_f32 v163, v163
    v_rcp_f32 v164, v164
    v_rcp_f32 v165, v165
    v_rcp_f32 v166, v166
    v_rcp_f32 v167, v167
    v_mul_f32 v160, v160, v112
    v_mul_f32 v161, v161, v113
    v_mul_f32 v162, v162, v114
    v_mul_f32 v163, v163, v115
    v_mul_f32 v164, v164, v116
    v_mul_f32 v165, v165, v117
    v_mul_f32 v166, v166, v118
    v_mul_f32 v167, v167, v119
    v_mul_f32 v160, v160, v120
    v_mul_f32 v161, v161, v121
    v_mul_f32 v162, v162, v122
    v_mul_f32 v163, v163, v123
    v_mul_f32 v164, v164, v124
    v_mul_f32 v165, v165, v125
    v_mul_f32 v166, v166, v126
    v_mul_f32 v167, v167, v127
    v_cvt_pk_bf16_f32 v184, v160, v161
    v_cvt_pk_bf16_f32 v185, v162, v163
    v_cvt_pk_bf16_f32 v186, v164, v165
    v_cvt_pk_bf16_f32 v187, v166, v167
    s_lshl_b32 s61, s49, 10
    s_add_u32 s61, s61, 65536
    s_cmp_lt_u32 s49, 22
    s_cselect_b32 s64, -1, 0
    v_and_b32 v184, s64, v184
    v_and_b32 v185, s64, v185
    v_and_b32 v186, s64, v186
    v_and_b32 v187, s64, v187
    s_cmp_lt_u32 s49, 24
    s_cselect_b32 s61, s61, 2147483632
    buffer_store_dwordx4 v[184:187], v15, s[44:47], s61 offen sc1
    s_mov_b32 s62, 0x3e0293ee
    s_mov_b32 s63, 0x42faf233
    s_mov_b32 s94, 0x3e0293ee
    s_mov_b32 s95, 0x3e0293ee
    v_lshrrev_b32 v15, 5, v1
    v_lshlrev_b32 v15, 10, v15
    v_sub_u32 v8, v8, v15
    v_add_u32 v8, 49152, v8
    v_sub_u32 v9, v9, v15
    v_add_u32 v9, 49152, v9
    v_sub_u32 v10, v10, v15
    v_add_u32 v10, 49152, v10
    v_sub_u32 v11, v11, v15
    v_add_u32 v11, 49152, v11
    v_mov_b32 v220, 0
    v_mov_b32 v221, 0
    s_waitcnt lgkmcnt(6)
    v_mfma_f32_32x32x16_bf16 v[80:95], v[128:131], v[224:227], 0
    v_mfma_f32_32x32x16_bf16 v[80:95], v[132:135], v[228:231], v[80:95]
    s_waitcnt lgkmcnt(4)
    v_mfma_f32_32x32x16_bf16 v[80:95], v[136:139], v[232:235], v[80:95]
    v_mfma_f32_32x32x16_bf16 v[80:95], v[140:143], v[236:239], v[80:95]
    s_waitcnt lgkmcnt(2)
    v_mfma_f32_32x32x16_bf16 v[80:95], v[144:147], v[240:243], v[80:95]
    v_mfma_f32_32x32x16_bf16 v[80:95], v[148:151], v[244:247], v[80:95]
    s_waitcnt lgkmcnt(0)
    v_mfma_f32_32x32x16_bf16 v[80:95], v[152:155], v[248:251], v[80:95]
    v_mfma_f32_32x32x16_bf16 v[80:95], v[156:159], v[252:255], v[80:95]
    ds_read_b128 v[128:131], v208 offset:8192
    s_nop 10
    v_max3_f32 v216, v80, v81, v82
    v_max3_f32 v216, v83, v84, v216
    ds_read_b128 v[132:135], v209 offset:8192
    s_add_u32 m0, s52, 49152
    s_add_u32 s61, s92, 0
    buffer_load_dwordx4 v6, s[36:39], s61 offen lds
    v_max3_f32 v216, v85, v86, v216
    v_max3_f32 v216, v87, v88, v216
    ds_read_b128 v[136:139], v210 offset:8192
    v_max3_f32 v216, v89, v90, v216
    v_max3_f32 v216, v91, v92, v216
    ds_read_b128 v[140:143], v211 offset:8192
    v_max3_f32 v216, v93, v94, v216
    v_max_f32 v216, v95, v216
    ds_read_b128 v[144:147], v212 offset:8192
    ds_read_b128 v[148:151], v213 offset:8192
    s_add_u32 m0, s52, 57344
    s_add_u32 s61, s92, 8192
    buffer_load_dwordx4 v6, s[36:39], s61 offen lds
    ds_read_b128 v[152:155], v214 offset:8192
    ds_read_b128 v[156:159], v215 offset:8192
    v_mov_b32 v223, v216
    s_nop 1
    v_permlane32_swap_b32 v216, v223
    v_max_f32 v216, v216, v223
    v_sub_f32 v80, v80, v216
    v_sub_f32 v81, v81, v216
    v_sub_f32 v82, v82, v216
    v_sub_f32 v83, v83, v216
    v_sub_f32 v84, v84, v216
    v_sub_f32 v85, v85, v216
    v_sub_f32 v86, v86, v216
    v_sub_f32 v87, v87, v216
    v_sub_f32 v88, v88, v216
    v_sub_f32 v89, v89, v216
    v_sub_f32 v90, v90, v216
    v_sub_f32 v91, v91, v216
    v_sub_f32 v92, v92, v216
    v_sub_f32 v93, v93, v216
    v_sub_f32 v94, v94, v216
    v_sub_f32 v95, v95, v216
    v_sub_f32 v192, 0, v216
    v_sub_f32 v193, 0, v216
    v_sub_f32 v194, 0, v216
    v_sub_f32 v195, 0, v216
    v_sub_f32 v196, 0, v216
    v_sub_f32 v197, 0, v216
    v_sub_f32 v198, 0, v216
    v_sub_f32 v199, 0, v216
    v_sub_f32 v200, 0, v216
    v_sub_f32 v201, 0, v216
    v_sub_f32 v202, 0, v216
    v_sub_f32 v203, 0, v216
    v_sub_f32 v204, 0, v216
    v_sub_f32 v205, 0, v216
    v_sub_f32 v206, 0, v216
    v_sub_f32 v207, 0, v216
    s_waitcnt lgkmcnt(6)
    s_nop 0
    v_mfma_f32_32x32x16_bf16 v[96:111], v[128:131], v[224:227], v[192:207]
    ds_read_b64_tr_b16 v[160:161], v8 offset:0
    ds_read_b64_tr_b16 v[162:163], v8 offset:2048
    v_exp_f32 v80, v80
    v_exp_f32 v81, v81
    v_add_f32 v220, v220, v80
    v_add_f32 v221, v221, v81
    v_cvt_pk_bf16_f32 v112, v80, v81
    v_mfma_f32_32x32x16_bf16 v[96:111], v[132:135], v[228:231], v[96:111]
    ds_read_b64_tr_b16 v[164:165], v9 offset:0
    ds_read_b64_tr_b16 v[166:167], v9 offset:2048
    v_exp_f32 v82, v82
    v_exp_f32 v83, v83
    v_add_f32 v220, v220, v82
    v_add_f32 v221, v221, v83
    v_cvt_pk_bf16_f32 v113, v82, v83
    s_waitcnt lgkmcnt(8)
    v_mfma_f32_32x32x16_bf16 v[96:111], v[136:139], v[232:235], v[96:111]
    ds_read_b64_tr_b16 v[168:169], v10 offset:0
    ds_read_b64_tr_b16 v[170:171], v10 offset:2048
    v_exp_f32 v84, v84
    v_exp_f32 v85, v85
    v_add_f32 v220, v220, v84
    v_add_f32 v221, v221, v85
    v_cvt_pk_bf16_f32 v114, v84, v85
    v_mfma_f32_32x32x16_bf16 v[96:111], v[140:143], v[236:239], v[96:111]
    ds_read_b64_tr_b16 v[172:173], v11 offset:0
    ds_read_b64_tr_b16 v[174:175], v11 offset:2048
    v_exp_f32 v86, v86
    v_exp_f32 v87, v87
    v_add_f32 v220, v220, v86
    v_add_f32 v221, v221, v87
    v_cvt_pk_bf16_f32 v115, v86, v87
    s_waitcnt lgkmcnt(10)
    v_mfma_f32_32x32x16_bf16 v[96:111], v[144:147], v[240:243], v[96:111]
    ds_read_b64_tr_b16 v[176:177], v8 offset:4096
    ds_read_b64_tr_b16 v[178:179], v8 offset:6144
    v_exp_f32 v88, v88
    v_exp_f32 v89, v89
    v_add_f32 v220, v220, v88
    v_add_f32 v221, v221, v89
    v_cvt_pk_bf16_f32 v116, v88, v89
    v_mfma_f32_32x32x16_bf16 v[96:111], v[148:151], v[244:247], v[96:111]
    ds_read_b64_tr_b16 v[180:181], v9 offset:4096
    ds_read_b64_tr_b16 v[182:183], v9 offset:6144
    v_exp_f32 v90, v90
    v_exp_f32 v91, v91
    v_add_f32 v220, v220, v90
    v_add_f32 v221, v221, v91
    v_cvt_pk_bf16_f32 v117, v90, v91
    s_waitcnt lgkmcnt(12)
    v_mfma_f32_32x32x16_bf16 v[96:111], v[152:155], v[248:251], v[96:111]
    ds_read_b64_tr_b16 v[184:185], v10 offset:4096
    ds_read_b64_tr_b16 v[186:187], v10 offset:6144
    v_exp_f32 v92, v92
    v_exp_f32 v93, v93
    v_add_f32 v220, v220, v92
    v_add_f32 v221, v221, v93
    v_cvt_pk_bf16_f32 v118, v92, v93
    v_mfma_f32_32x32x16_bf16 v[96:111], v[156:159], v[252:255], v[96:111]
    ds_read_b64_tr_b16 v[188:189], v11 offset:4096
    ds_read_b64_tr_b16 v[190:191], v11 offset:6144
    v_exp_f32 v94, v94
    v_exp_f32 v95, v95
    v_add_f32 v220, v220, v94
    v_add_f32 v221, v221, v95
    v_cvt_pk_bf16_f32 v119, v94, v95
    s_waitcnt lgkmcnt(12)
    v_mfma_f32_32x32x16_bf16 v[16:31], v[160:163], v[112:115], 0
    s_waitcnt vmcnt(11)
    s_barrier
    v_add_u32 v208, 32768, v208
    v_add_u32 v209, 32768, v209
    v_add_u32 v210, 32768, v210
    v_add_u32 v211, 32768, v211
    v_add_u32 v212, 32768, v212
    v_add_u32 v213, 32768, v213
    v_add_u32 v214, 32768, v214
    v_add_u32 v215, 32768, v215
    ds_read_b128 v[128:131], v208 offset:0
    v_mfma_f32_32x32x16_bf16 v[32:47], v[164:167], v[112:115], 0
    ds_read_b128 v[132:135], v209 offset:0
    s_add_u32 s92, s91, 4
    s_and_b32 s92, s92, 7
    s_lshl_b32 s92, s92, 14
    s_add_u32 s92, s92, s52
    s_add_u32 m0, s52, 65536
    s_add_u32 s61, s92, 0
    buffer_load_dwordx4 v5, s[32:35], s61 offen lds
    s_waitcnt lgkmcnt(10)
    v_mfma_f32_32x32x16_bf16 v[48:63], v[168:171], v[112:115], 0
    ds_read_b128 v[136:139], v210 offset:0
    v_mfma_f32_32x32x16_bf16 v[64:79], v[172:175], v[112:115], 0
    ds_read_b128 v[140:143], v211 offset:0
    v_max3_f32 v216, v96, v97, v98
    v_max3_f32 v216, v99, v100, v216
    s_waitcnt lgkmcnt(8)
    v_mfma_f32_32x32x16_bf16 v[16:31], v[176:179], v[116:119], v[16:31]
    ds_read_b128 v[144:147], v212 offset:0
    v_max3_f32 v216, v101, v102, v216
    v_max3_f32 v216, v103, v104, v216
    v_mfma_f32_32x32x16_bf16 v[32:47], v[180:183], v[116:119], v[32:47]
    ds_read_b128 v[148:151], v213 offset:0
    s_add_u32 m0, s52, 73728
    s_add_u32 s61, s92, 8192
    buffer_load_dwordx4 v5, s[32:35], s61 offen lds
    v_max3_f32 v216, v105, v106, v216
    v_max3_f32 v216, v107, v108, v216
    s_waitcnt lgkmcnt(6)
    v_mfma_f32_32x32x16_bf16 v[48:63], v[184:187], v[116:119], v[48:63]
    ds_read_b128 v[152:155], v214 offset:0
    v_max3_f32 v216, v109, v110, v216
    v_max_f32 v216, v111, v216
    v_mfma_f32_32x32x16_bf16 v[64:79], v[188:191], v[116:119], v[64:79]
    ds_read_b128 v[156:159], v215 offset:0
    v_cmp_lt_f32 vcc, 0x41800000, v216
    s_nop 4
    s_cbranch_vccnz L_at_rare1
L_at_back1:
    s_waitcnt lgkmcnt(6)
    v_mfma_f32_32x32x16_bf16 v[80:95], v[128:131], v[224:227], v[192:207]
    ds_read_b64_tr_b16 v[160:161], v8 offset:8192
    ds_read_b64_tr_b16 v[162:163], v8 offset:10240
    v_exp_f32 v96, v96
    v_exp_f32 v97, v97
    v_add_f32 v220, v220, v96
    v_add_f32 v221, v221, v97
    v_cvt_pk_bf16_f32 v120, v96, v97
    v_mfma_f32_32x32x16_bf16 v[80:95], v[132:135], v[228:231], v[80:95]
    ds_read_b64_tr_b16 v[164:165], v9 offset:8192
    ds_read_b64_tr_b16 v[166:167], v9 offset:10240
    v_exp_f32 v98, v98
    v_exp_f32 v99, v99
    v_add_f32 v220, v220, v98
    v_add_f32 v221, v221, v99
    v_cvt_pk_bf16_f32 v121, v98, v99
    s_waitcnt lgkmcnt(8)
    v_mfma_f32_32x32x16_bf16 v[80:95], v[136:139], v[232:235], v[80:95]
    ds_read_b64_tr_b16 v[168:169], v10 offset:8192
    ds_read_b64_tr_b16 v[170:171], v10 offset:10240
    v_exp_f32 v100, v100
    v_exp_f32 v101, v101
    v_add_f32 v220, v220, v100
    v_add_f32 v221, v221, v101
    v_cvt_pk_bf16_f32 v122, v100, v101
    v_mfma_f32_32x32x16_bf16 v[80:95], v[140:143], v[236:239], v[80:95]
    ds_read_b64_tr_b16 v[172:173], v11 offset:8192
    ds_read_b64_tr_b16 v[174:175], v11 offset:10240
    v_exp_f32 v102, v102
    v_exp_f32 v103, v103
    v_add_f32 v220, v220, v102
    v_add_f32 v221, v221, v103
    v_cvt_pk_bf16_f32 v123, v102, v103
    s_waitcnt lgkmcnt(10)
    v_mfma_f32_32x32x16_bf16 v[80:95], v[144:147], v[240:243], v[80:95]
    ds_read_b64_tr_b16 v[176:177], v8 offset:12288
    ds_read_b64_tr_b16 v[178:179], v8 offset:14336
    v_exp_f32 v104, v104
    v_exp_f32 v105, v105
    v_add_f32 v220, v220, v104
    v_add_f32 v221, v221, v105
    v_cvt_pk_bf16_f32 v124, v104, v105
    v_mfma_f32_32x32x16_bf16 v[80:95], v[148:151], v[244:247], v[80:95]
    ds_read_b64_tr_b16 v[180:181], v9 offset:12288
    ds_read_b64_tr_b16 v[182:183], v9 offset:14336
    v_exp_f32 v106, v106
    v_exp_f32 v107, v107
    v_add_f32 v220, v220, v106
    v_add_f32 v221, v221, v107
    v_cvt_pk_bf16_f32 v125, v106, v107
    s_waitcnt lgkmcnt(12)
    v_mfma_f32_32x32x16_bf16 v[80:95], v[152:155], v[248:251], v[80:95]
    ds_read_b64_tr_b16 v[184:185], v10 offset:12288
    ds_read_b64_tr_b16 v[186:187], v10 offset:14336
    v_exp_f32 v108, v108
    v_exp_f32 v109, v109
    v_add_f32 v220, v220, v108
    v_add_f32 v221, v221, v109
    v_cvt_pk_bf16_f32 v126, v108, v109
    v_mfma_f32_32x32x16_bf16 v[80:95], v[156:159], v[252:255], v[80:95]
    ds_read_b64_tr_b16 v[188:189], v11 offset:12288
    ds_read_b64_tr_b16 v[190:191], v11 offset:14336
    v_exp_f32 v110, v110
    v_exp_f32 v111, v111
    v_add_f32 v220, v220, v110
    v_add_f32 v221, v221, v111
    v_cvt_pk_bf16_f32 v127, v110, v111
    s_waitcnt lgkmcnt(12)
    v_mfma_f32_32x32x16_bf16 v[16:31], v[160:163], v[120:123], v[16:31]
    ds_read_b128 v[128:131], v208 offset:8192
    v_mfma_f32_32x32x16_bf16 v[32:47], v[164:167], v[120:123], v[32:47]
    ds_read_b128 v[132:135], v209 offset:8192
    s_add_u32 m0, s52, 81920
    s_add_u32 s61, s92, 0
    buffer_load_dwordx4 v6, s[36:39], s61 offen lds
    s_waitcnt lgkmcnt(10)
    v_mfma_f32_32x32x16_bf16 v[48:63], v[168:171], v[120:123], v[48:63]
    ds_read_b128 v[136:139], v210 offset:8192
    v_mfma_f32_32x32x16_bf16 v[64:79], v[172:175], v[120:123], v[64:79]
    ds_read_b128 v[140:143], v211 offset:8192
    v_max3_f32 v216, v80, v81, v82
    v_max3_f32 v216, v83, v84, v216
    s_waitcnt lgkmcnt(8)
    v_mfma_f32_32x32x16_bf16 v[16:31], v[176:179], v[124:127], v[16:31]
    ds_read_b128 v[144:147], v212 offset:8192
    v_max3_f32 v216, v85, v86, v216
    v_max3_f32 v216, v87, v88, v216
    v_mfma_f32_32x32x16_bf16 v[32:47], v[180:183], v[124:127], v[32:47]
    ds_read_b128 v[148:151], v213 offset:8192
    s_add_u32 m0, s52, 90112
    s_add_u32 s61, s92, 8192
    buffer_load_dwordx4 v6, s[36:39], s61 offen lds
    v_max3_f32 v216, v89, v90, v216
    v_max3_f32 v216, v91, v92, v216
    s_waitcnt lgkmcnt(6)
    v_mfma_f32_32x32x16_bf16 v[48:63], v[184:187], v[124:127], v[48:63]
    ds_read_b128 v[152:155], v214 offset:8192
    v_max3_f32 v216, v93, v94, v216
    v_max_f32 v216, v95, v216
    v_mfma_f32_32x32x16_bf16 v[64:79], v[188:191], v[124:127], v[64:79]
    ds_read_b128 v[156:159], v215 offset:8192
    v_cmp_lt_f32 vcc, 0x41800000, v216
    s_nop 4
    s_cbranch_vccnz L_at_rare2
L_at_back2:
    s_waitcnt lgkmcnt(6)
    v_mfma_f32_32x32x16_bf16 v[96:111], v[128:131], v[224:227], v[192:207]
    v_add_u32 v8, 32768, v8
    v_add_u32 v9, 32768, v9
    v_add_u32 v10, 32768, v10
    v_add_u32 v11, 32768, v11
    ds_read_b64_tr_b16 v[160:161], v8 offset:0
    ds_read_b64_tr_b16 v[162:163], v8 offset:2048
    v_exp_f32 v80, v80
    v_exp_f32 v81, v81
    v_add_f32 v220, v220, v80
    v_add_f32 v221, v221, v81
    v_cvt_pk_bf16_f32 v112, v80, v81
    v_mfma_f32_32x32x16_bf16 v[96:111], v[132:135], v[228:231], v[96:111]
    ds_read_b64_tr_b16 v[164:165], v9 offset:0
    ds_read_b64_tr_b16 v[166:167], v9 offset:2048
    v_exp_f32 v82, v82
    v_exp_f32 v83, v83
    v_add_f32 v220, v220, v82
    v_add_f32 v221, v221, v83
    v_cvt_pk_bf16_f32 v113, v82, v83
    s_waitcnt lgkmcnt(8)
    v_mfma_f32_32x32x16_bf16 v[96:111], v[136:139], v[232:235], v[96:111]
    ds_read_b64_tr_b16 v[168:169], v10 offset:0
    ds_read_b64_tr_b16 v[170:171], v10 offset:2048
    v_exp_f32 v84, v84
    v_exp_f32 v85, v85
    v_add_f32 v220, v220, v84
    v_add_f32 v221, v221, v85
    v_cvt_pk_bf16_f32 v114, v84, v85
    v_mfma_f32_32x32x16_bf16 v[96:111], v[140:143], v[236:239], v[96:111]
    ds_read_b64_tr_b16 v[172:173], v11 offset:0
    ds_read_b64_tr_b16 v[174:175], v11 offset:2048
    v_exp_f32 v86, v86
    v_exp_f32 v87, v87
    v_add_f32 v220, v220, v86
    v_add_f32 v221, v221, v87
    v_cvt_pk_bf16_f32 v115, v86, v87
    s_waitcnt lgkmcnt(10)
    v_mfma_f32_32x32x16_bf16 v[96:111], v[144:147], v[240:243], v[96:111]
    ds_read_b64_tr_b16 v[176:177], v8 offset:4096
    ds_read_b64_tr_b16 v[178:179], v8 offset:6144
    v_exp_f32 v88, v88
    v_exp_f32 v89, v89
    v_add_f32 v220, v220, v88
    v_add_f32 v221, v221, v89
    v_cvt_pk_bf16_f32 v116, v88, v89
    v_mfma_f32_32x32x16_bf16 v[96:111], v[148:151], v[244:247], v[96:111]
    ds_read_b64_tr_b16 v[180:181], v9 offset:4096
    ds_read_b64_tr_b16 v[182:183], v9 offset:6144
    v_exp_f32 v90, v90
    v_exp_f32 v91, v91
    v_add_f32 v220, v220, v90
    v_add_f32 v221, v221, v91
    v_cvt_pk_bf16_f32 v117, v90, v91
    s_waitcnt lgkmcnt(12)
    v_mfma_f32_32x32x16_bf16 v[96:111], v[152:155], v[248:251], v[96:111]
    ds_read_b64_tr_b16 v[184:185], v10 offset:4096
    ds_read_b64_tr_b16 v[186:187], v10 offset:6144
    v_exp_f32 v92, v92
    v_exp_f32 v93, v93
    v_add_f32 v220, v220, v92
    v_add_f32 v221, v221, v93
    v_cvt_pk_bf16_f32 v118, v92, v93
    v_mfma_f32_32x32x16_bf16 v[96:111], v[156:159], v[252:255], v[96:111]
    ds_read_b64_tr_b16 v[188:189], v11 offset:4096
    ds_read_b64_tr_b16 v[190:191], v11 offset:6144
    v_exp_f32 v94, v94
    v_exp_f32 v95, v95
    v_add_f32 v220, v220, v94
    v_add_f32 v221, v221, v95
    v_cvt_pk_bf16_f32 v119, v94, v95
    s_waitcnt lgkmcnt(12)
    v_mfma_f32_32x32x16_bf16 v[16:31], v[160:163], v[112:115], v[16:31]
    s_waitcnt vmcnt(11)
    s_barrier
    v_add_u32 v208, 4294836224, v208
    v_add_u32 v209, 4294836224, v209
    v_add_u32 v210, 4294836224, v210
    v_add_u32 v211, 4294836224, v211
    v_add_u32 v212, 4294836224, v212
    v_add_u32 v213, 4294836224, v213
    v_add_u32 v214, 4294836224, v214
    v_add_u32 v215, 4294836224, v215
    ds_read_b128 v[128:131], v208 offset:0
    v_mfma_f32_32x32x16_bf16 v[32:47], v[164:167], v[112:115], v[32:47]
    ds_read_b128 v[132:135], v209 offset:0
    s_add_u32 s92, s91, 5
    s_and_b32 s92, s92, 7
    s_lshl_b32 s92, s92, 14
    s_add_u32 s92, s92, s52
    s_add_u32 m0, s52, 98304
    s_add_u32 s61, s92, 0
    buffer_load_dwordx4 v5, s[32:35], s61 offen lds
    s_waitcnt lgkmcnt(10)
    v_mfma_f32_32x32x16_bf16 v[48:63], v[168:171], v[112:115], v[48:63]
    ds_read_b128 v[136:139], v210 offset:0
    v_mfma_f32_32x32x16_bf16 v[64:79], v[172:175], v[112:115], v[64:79]
    ds_read_b128 v[140:143], v211 offset:0
    v_max3_f32 v216, v96, v97, v98
    v_max3_f32 v216, v99, v100, v216
    s_waitcnt lgkmcnt(8)
    v_mfma_f32_32x32x16_bf16 v[16:31], v[176:179], v[116:119], v[16:31]
    ds_read_b128 v[144:147], v212 offset:0
    v_max3_f32 v216, v101, v102, v216
    v_max3_f32 v216, v103, v104, v216
    v_mfma_f32_32x32x16_bf16 v[32:47], v[180:183], v[116:119], v[32:47]
    ds_read_b128 v[148:151], v213 offset:0
    s_add_u32 m0, s52, 106496
    s_add_u32 s61, s92, 8192
    buffer_load_dwordx4 v5, s[32:35], s61 offen lds
    v_max3_f32 v216, v105, v106, v216
    v_max3_f32 v216, v107, v108, v216
    s_waitcnt lgkmcnt(6)
    v_mfma_f32_32x32x16_bf16 v[48:63], v[184:187], v[116:119], v[48:63]
    ds_read_b128 v[152:155], v214 offset:0
    v_max3_f32 v216, v109, v110, v216
    v_max_f32 v216, v111, v216
    v_mfma_f32_32x32x16_bf16 v[64:79], v[188:191], v[116:119], v[64:79]
    ds_read_b128 v[156:159], v215 offset:0
    v_cmp_lt_f32 vcc, 0x41800000, v216
    s_nop 4
    s_cbranch_vccnz L_at_rare3
L_at_back3:
    s_waitcnt lgkmcnt(6)
    v_mfma_f32_32x32x16_bf16 v[80:95], v[128:131], v[224:227], v[192:207]
    ds_read_b64_tr_b16 v[160:161], v8 offset:8192
    ds_read_b64_tr_b16 v[162:163], v8 offset:10240
    v_exp_f32 v96, v96
    v_exp_f32 v97, v97
    v_add_f32 v220, v220, v96
    v_add_f32 v221, v221, v97
    v_cvt_pk_bf16_f32 v120, v96, v97
    v_mfma_f32_32x32x16_bf16 v[80:95], v[132:135], v[228:231], v[80:95]
    ds_read_b64_tr_b16 v[164:165], v9 offset:8192
    ds_read_b64_tr_b16 v[166:167], v9 offset:10240
    v_exp_f32 v98, v98
    v_exp_f32 v99, v99
    v_add_f32 v220, v220, v98
    v_add_f32 v221, v221, v99
    v_cvt_pk_bf16_f32 v121, v98, v99
    s_waitcnt lgkmcnt(8)
    v_mfma_f32_32x32x16_bf16 v[80:95], v[136:139], v[232:235], v[80:95]
    ds_read_b64_tr_b16 v[168:169], v10 offset:8192
    ds_read_b64_tr_b16 v[170:171], v10 offset:10240
    v_exp_f32 v100, v100
    v_exp_f32 v101, v101
    v_add_f32 v220, v220, v100
    v_add_f32 v221, v221, v101
    v_cvt_pk_bf16_f32 v122, v100, v101
    v_mfma_f32_32x32x16_bf16 v[80:95], v[140:143], v[236:239], v[80:95]
    ds_read_b64_tr_b16 v[172:173], v11 offset:8192
    ds_read_b64_tr_b16 v[174:175], v11 offset:10240
    v_exp_f32 v102, v102
    v_exp_f32 v103, v103
    v_add_f32 v220, v220, v102
    v_add_f32 v221, v221, v103
    v_cvt_pk_bf16_f32 v123, v102, v103
    s_waitcnt lgkmcnt(10)
    v_mfma_f32_32x32x16_bf16 v[80:95], v[144:147], v[240:243], v[80:95]
    ds_read_b64_tr_b16 v[176:177], v8 offset:12288
    ds_read_b64_tr_b16 v[178:179], v8 offset:14336
    v_exp_f32 v104, v104
    v_exp_f32 v105, v105
    v_add_f32 v220, v220, v104
    v_add_f32 v221, v221, v105
    v_cvt_pk_bf16_f32 v124, v104, v105
    v_mfma_f32_32x32x16_bf16 v[80:95], v[148:151], v[244:247], v[80:95]
    ds_read_b64_tr_b16 v[180:181], v9 offset:12288
    ds_read_b64_tr_b16 v[182:183], v9 offset:14336
    v_exp_f32 v106, v106
    v_exp_f32 v107, v107
    v_add_f32 v220, v220, v106
    v_add_f32 v221, v221, v107
    v_cvt_pk_bf16_f32 v125, v106, v107
    s_waitcnt lgkmcnt(12)
    v_mfma_f32_32x32x16_bf16 v[80:95], v[152:155], v[248:251], v[80:95]
    ds_read_b64_tr_b16 v[184:185], v10 offset:12288
    ds_read_b64_tr_b16 v[186:187], v10 offset:14336
    v_exp_f32 v108, v108
    v_exp_f32 v109, v109
    v_add_f32 v220, v220, v108
    v_add_f32 v221, v221, v109
    v_cvt_pk_bf16_f32 v126, v108, v109
    v_mfma_f32_32x32x16_bf16 v[80:95], v[156:159], v[252:255], v[80:95]
    ds_read_b64_tr_b16 v[188:189], v11 offset:12288
    ds_read_b64_tr_b16 v[190:191], v11 offset:14336
    v_exp_f32 v110, v110
    v_exp_f32 v111, v111
    v_add_f32 v220, v220, v110
    v_add_f32 v221, v221, v111
    v_cvt_pk_bf16_f32 v127, v110, v111
    s_waitcnt lgkmcnt(12)
    v_mfma_f32_32x32x16_bf16 v[16:31], v[160:163], v[120:123], v[16:31]
    ds_read_b128 v[128:131], v208 offset:8192
    v_mfma_f32_32x32x16_bf16 v[32:47], v[164:167], v[120:123], v[32:47]
    ds_read_b128 v[132:135], v209 offset:8192
    s_add_u32 m0, s52, 114688
    s_add_u32 s61, s92, 0
    buffer_load_dwordx4 v6, s[36:39], s61 offen lds
    s_waitcnt lgkmcnt(10)
    v_mfma_f32_32x32x16_bf16 v[48:63], v[168:171], v[120:123], v[48:63]
    ds_read_b128 v[136:139], v210 offset:8192
    v_mfma_f32_32x32x16_bf16 v[64:79], v[172:175], v[120:123], v[64:79]
    ds_read_b128 v[140:143], v211 offset:8192
    v_max3_f32 v216, v80, v81, v82
    v_max3_f32 v216, v83, v84, v216
    s_waitcnt lgkmcnt(8)
    v_mfma_f32_32x32x16_bf16 v[16:31], v[176:179], v[124:127], v[16:31]
    ds_read_b128 v[144:147], v212 offset:8192
    v_max3_f32 v216, v85, v86, v216
    v_max3_f32 v216, v87, v88, v216
    v_mfma_f32_32x32x16_bf16 v[32:47], v[180:183], v[124:127], v[32:47]
    ds_read_b128 v[148:151], v213 offset:8192
    s_add_u32 m0, s52, 122880
    s_add_u32 s61, s92, 8192
    buffer_load_dwordx4 v6, s[36:39], s61 offen lds
    v_max3_f32 v216, v89, v90, v216
    v_max3_f32 v216, v91, v92, v216
    s_waitcnt lgkmcnt(6)
    v_mfma_f32_32x32x16_bf16 v[48:63], v[184:187], v[124:127], v[48:63]
    ds_read_b128 v[152:155], v214 offset:8192
    v_max3_f32 v216, v93, v94, v216
    v_max_f32 v216, v95, v216
    v_mfma_f32_32x32x16_bf16 v[64:79], v[188:191], v[124:127], v[64:79]
    ds_read_b128 v[156:159], v215 offset:8192
    v_cmp_lt_f32 vcc, 0x41800000, v216
    s_nop 4
    s_cbranch_vccnz L_at_rare4
L_at_back4:
    s_waitcnt lgkmcnt(6)
    v_mfma_f32_32x32x16_bf16 v[96:111], v[128:131], v[224:227], v[192:207]
    v_add_u32 v8, 4294836224, v8
    v_add_u32 v9, 4294836224, v9
    v_add_u32 v10, 4294836224, v10
    v_add_u32 v11, 4294836224, v11
    ds_read_b64_tr_b16 v[160:161], v8 offset:0
    ds_read_b64_tr_b16 v[162:163], v8 offset:2048
    v_exp_f32 v80, v80
    v_exp_f32 v81, v81
    v_add_f32 v220, v220, v80
    v_add_f32 v221, v221, v81
    v_cvt_pk_bf16_f32 v112, v80, v81
    v_mfma_f32_32x32x16_bf16 v[96:111], v[132:135], v[228:231], v[96:111]
    ds_read_b64_tr_b16 v[164:165], v9 offset:0
    ds_read_b64_tr_b16 v[166:167], v9 offset:2048
    v_exp_f32 v82, v82
    v_exp_f32 v83, v83
    v_add_f32 v220, v220, v82
    v_add_f32 v221, v221, v83
    v_cvt_pk_bf16_f32 v113, v82, v83
    s_waitcnt lgkmcnt(8)
    v_mfma_f32_32x32x16_bf16 v[96:111], v[136:139], v[232:235], v[96:111]
    ds_read_b64_tr_b16 v[168:169], v10 offset:0
    ds_read_b64_tr_b16 v[170:171], v10 offset:2048
    v_exp_f32 v84, v84
    v_exp_f32 v85, v85
    v_add_f32 v220, v220, v84
    v_add_f32 v221, v221, v85
    v_cvt_pk_bf16_f32 v114, v84, v85
    v_mfma_f32_32x32x16_bf16 v[96:111], v[140:143], v[236:239], v[96:111]
    ds_read_b64_tr_b16 v[172:173], v11 offset:0
    ds_read_b64_tr_b16 v[174:175], v11 offset:2048
    v_exp_f32 v86, v86
    v_exp_f32 v87, v87
    v_add_f32 v220, v220, v86
    v_add_f32 v221, v221, v87
    v_cvt_pk_bf16_f32 v115, v86, v87
    s_waitcnt lgkmcnt(10)
    v_mfma_f32_32x32x16_bf16 v[96:111], v[144:147], v[240:243], v[96:111]
    ds_read_b64_tr_b16 v[176:177], v8 offset:4096
    ds_read_b64_tr_b16 v[178:179], v8 offset:6144
    v_exp_f32 v88, v88
    v_exp_f32 v89, v89
    v_add_f32 v220, v220, v88
    v_add_f32 v221, v221, v89
    v_cvt_pk_bf16_f32 v116, v88, v89
    v_mfma_f32_32x32x16_bf16 v[96:111], v[148:151], v[244:247], v[96:111]
    ds_read_b64_tr_b16 v[180:181], v9 offset:4096
    ds_read_b64_tr_b16 v[182:183], v9 offset:6144
    v_exp_f32 v90, v90
    v_exp_f32 v91, v91
    v_add_f32 v220, v220, v90
    v_add_f32 v221, v221, v91
    v_cvt_pk_bf16_f32 v117, v90, v91
    s_waitcnt lgkmcnt(12)
    v_mfma_f32_32x32x16_bf16 v[96:111], v[152:155], v[248:251], v[96:111]
    ds_read_b64_tr_b16 v[184:185], v10 offset:4096
    ds_read_b64_tr_b16 v[186:187], v10 offset:6144
    v_exp_f32 v92, v92
    v_exp_f32 v93, v93
    v_add_f32 v220, v220, v92
    v_add_f32 v221, v221, v93
    v_cvt_pk_bf16_f32 v118, v92, v93
    v_mfma_f32_32x32x16_bf16 v[96:111], v[156:159], v[252:255], v[96:111]
    ds_read_b64_tr_b16 v[188:189], v11 offset:4096
    ds_read_b64_tr_b16 v[190:191], v11 offset:6144
    v_exp_f32 v94, v94
    v_exp_f32 v95, v95
    v_add_f32 v220, v220, v94
    v_add_f32 v221, v221, v95
    v_cvt_pk_bf16_f32 v119, v94, v95
    s_waitcnt lgkmcnt(12)
    v_mfma_f32_32x32x16_bf16 v[16:31], v[160:163], v[112:115], v[16:31]
    s_waitcnt vmcnt(8)
    s_barrier
    v_add_u32 v208, 32768, v208
    v_add_u32 v209, 32768, v209
    v_add_u32 v210, 32768, v210
    v_add_u32 v211, 32768, v211
    v_add_u32 v212, 32768, v212
    v_add_u32 v213, 32768, v213
    v_add_u32 v214, 32768, v214
    v_add_u32 v215, 32768, v215
    ds_read_b128 v[128:131], v208 offset:0
    v_mfma_f32_32x32x16_bf16 v[32:47], v[164:167], v[112:115], v[32:47]
    ds_read_b128 v[132:135], v209 offset:0
    s_add_u32 s92, s91, 6
    s_and_b32 s92, s92, 7
    s_lshl_b32 s92, s92, 14
    s_add_u32 s92, s92, s52
    s_add_u32 m0, s52, 131072
    s_add_u32 s61, s92, 0
    buffer_load_dwordx4 v5, s[32:35], s61 offen lds
    s_waitcnt lgkmcnt(10)
    v_mfma_f32_32x32x16_bf16 v[48:63], v[168:171], v[112:115], v[48:63]
    ds_read_b128 v[136:139], v210 offset:0
    v_mfma_f32_32x32x16_bf16 v[64:79], v[172:175], v[112:115], v[64:79]
    ds_read_b128 v[140:143], v211 offset:0
    v_max3_f32 v216, v96, v97, v98
    v_max3_f32 v216, v99, v100, v216
    s_waitcnt lgkmcnt(8)
    v_mfma_f32_32x32x16_bf16 v[16:31], v[176:179], v[116:119], v[16:31]
    ds_read_b128 v[144:147], v212 offset:0
    v_max3_f32 v216, v101, v102, v216
    v_max3_f32 v216, v103, v104, v216
    v_mfma_f32_32x32x16_bf16 v[32:47], v[180:183], v[116:119], v[32:47]
    ds_read_b128 v[148:151], v213 offset:0
    s_add_u32 m0, s52, 139264
    s_add_u32 s61, s92, 8192
    buffer_load_dwordx4 v5, s[32:35], s61 offen lds
    v_max3_f32 v216, v105, v106, v216
    v_max3_f32 v216, v107, v108, v216
    s_waitcnt lgkmcnt(6)
    v_mfma_f32_32x32x16_bf16 v[48:63], v[184:187], v[116:119], v[48:63]
    ds_read_b128 v[152:155], v214 offset:0
    v_max3_f32 v216, v109, v110, v216
    v_max_f32 v216, v111, v216
    v_mfma_f32_32x32x16_bf16 v[64:79], v[188:191], v[116:119], v[64:79]
    ds_read_b128 v[156:159], v215 offset:0
    v_cmp_lt_f32 vcc, 0x41800000, v216
    s_nop 4
    s_cbranch_vccnz L_at_rare5
L_at_back5:
    s_waitcnt lgkmcnt(6)
    v_mfma_f32_32x32x16_bf16 v[80:95], v[128:131], v[224:227], v[192:207]
    ds_read_b64_tr_b16 v[160:161], v8 offset:8192
    ds_read_b64_tr_b16 v[162:163], v8 offset:10240
    v_exp_f32 v96, v96
    v_exp_f32 v97, v97
    v_add_f32 v220, v220, v96
    v_add_f32 v221, v221, v97
    v_cvt_pk_bf16_f32 v120, v96, v97
    v_mfma_f32_32x32x16_bf16 v[80:95], v[132:135], v[228:231], v[80:95]
    ds_read_b64_tr_b16 v[164:165], v9 offset:8192
    ds_read_b64_tr_b16 v[166:167], v9 offset:10240
    v_exp_f32 v98, v98
    v_exp_f32 v99, v99
    v_add_f32 v220, v220, v98
    v_add_f32 v221, v221, v99
    v_cvt_pk_bf16_f32 v121, v98, v99
    s_waitcnt lgkmcnt(8)
    v_mfma_f32_32x32x16_bf16 v[80:95], v[136:139], v[232:235], v[80:95]
    ds_read_b64_tr_b16 v[168:169], v10 offset:8192
    ds_read_b64_tr_b16 v[170:171], v10 offset:10240
    v_exp_f32 v100, v100
    v_exp_f32 v101, v101
    v_add_f32 v220, v220, v100
    v_add_f32 v221, v221, v101
    v_cvt_pk_bf16_f32 v122, v100, v101
    v_mfma_f32_32x32x16_bf16 v[80:95], v[140:143], v[236:239], v[80:95]
    ds_read_b64_tr_b16 v[172:173], v11 offset:8192
    ds_read_b64_tr_b16 v[174:175], v11 offset:10240
    v_exp_f32 v102, v102
    v_exp_f32 v103, v103
    v_add_f32 v220, v220, v102
    v_add_f32 v221, v221, v103
    v_cvt_pk_bf16_f32 v123, v102, v103
    s_waitcnt lgkmcnt(10)
    v_mfma_f32_32x32x16_bf16 v[80:95], v[144:147], v[240:243], v[80:95]
    ds_read_b64_tr_b16 v[176:177], v8 offset:12288
    ds_read_b64_tr_b16 v[178:179], v8 offset:14336
    v_exp_f32 v104, v104
    v_exp_f32 v105, v105
    v_add_f32 v220, v220, v104
    v_add_f32 v221, v221, v105
    v_cvt_pk_bf16_f32 v124, v104, v105
    v_mfma_f32_32x32x16_bf16 v[80:95], v[148:151], v[244:247], v[80:95]
    ds_read_b64_tr_b16 v[180:181], v9 offset:12288
    ds_read_b64_tr_b16 v[182:183], v9 offset:14336
    v_exp_f32 v106, v106
    v_exp_f32 v107, v107
    v_add_f32 v220, v220, v106
    v_add_f32 v221, v221, v107
    v_cvt_pk_bf16_f32 v125, v106, v107
    s_waitcnt lgkmcnt(12)
    v_mfma_f32_32x32x16_bf16 v[80:95], v[152:155], v[248:251], v[80:95]
    ds_read_b64_tr_b16 v[184:185], v10 offset:12288
    ds_read_b64_tr_b16 v[186:187], v10 offset:14336
    v_exp_f32 v108, v108
    v_exp_f32 v109, v109
    v_add_f32 v220, v220, v108
    v_add_f32 v221, v221, v109
    v_cvt_pk_bf16_f32 v126, v108, v109
    v_mfma_f32_32x32x16_bf16 v[80:95], v[156:159], v[252:255], v[80:95]
    ds_read_b64_tr_b16 v[188:189], v11 offset:12288
    ds_read_b64_tr_b16 v[190:191], v11 offset:14336
    v_exp_f32 v110, v110
    v_exp_f32 v111, v111
    v_add_f32 v220, v220, v110
    v_add_f32 v221, v221, v111
    v_cvt_pk_bf16_f32 v127, v110, v111
    s_waitcnt lgkmcnt(12)
    v_mfma_f32_32x32x16_bf16 v[16:31], v[160:163], v[120:123], v[16:31]
    ds_read_b128 v[128:131], v208 offset:8192
    v_mfma_f32_32x32x16_bf16 v[32:47], v[164:167], v[120:123], v[32:47]
    ds_read_b128 v[132:135], v209 offset:8192
    s_add_u32 m0, s52, 147456
    s_add_u32 s61, s92, 0
    buffer_load_dwordx4 v6, s[36:39], s61 offen lds
    s_waitcnt lgkmcnt(10)
    v_mfma_f32_32x32x16_bf16 v[48:63], v[168:171], v[120:123], v[48:63]
    ds_read_b128 v[136:139], v210 offset:8192
    v_mfma_f32_32x32x16_bf16 v[64:79], v[172:175], v[120:123], v[64:79]
    ds_read_b128 v[140:143], v211 offset:8192
    v_max3_f32 v216, v80, v81, v82
    v_max3_f32 v216, v83, v84, v216
    s_waitcnt lgkmcnt(8)
    v_mfma_f32_32x32x16_bf16 v[16:31], v[176:179], v[124:127], v[16:31]
    ds_read_b128 v[144:147], v212 offset:8192
    v_max3_f32 v216, v85, v86, v216
    v_max3_f32 v216, v87, v88, v216
    v_mfma_f32_32x32x16_bf16 v[32:47], v[180:183], v[124:127], v[32:47]
    ds_read_b128 v[148:151], v213 offset:8192
    s_add_u32 m0, s52, 155648
    s_add_u32 s61, s92, 8192
    buffer_load_dwordx4 v6, s[36:39], s61 offen lds
    v_max3_f32 v216, v89, v90, v216
    v_max3_f32 v216, v91, v92, v216
    s_waitcnt lgkmcnt(6)
    v_mfma_f32_32x32x16_bf16 v[48:63], v[184:187], v[124:127], v[48:63]
    ds_read_b128 v[152:155], v214 offset:8192
    v_max3_f32 v216, v93, v94, v216
    v_max_f32 v216, v95, v216
    v_mfma_f32_32x32x16_bf16 v[64:79], v[188:191], v[124:127], v[64:79]
    ds_read_b128 v[156:159], v215 offset:8192
    v_cmp_lt_f32 vcc, 0x41800000, v216
    s_nop 4
    s_cbranch_vccnz L_at_rare6
L_at_back6:
    s_waitcnt lgkmcnt(6)
    v_mfma_f32_32x32x16_bf16 v[96:111], v[128:131], v[224:227], v[192:207]
    v_add_u32 v8, 32768, v8
    v_add_u32 v9, 32768, v9
    v_add_u32 v10, 32768, v10
    v_add_u32 v11, 32768, v11
    ds_read_b64_tr_b16 v[160:161], v8 offset:0
    ds_read_b64_tr_b16 v[162:163], v8 offset:2048
    v_exp_f32 v80, v80
    v_exp_f32 v81, v81
    v_add_f32 v220, v220, v80
    v_add_f32 v221, v221, v81
    v_cvt_pk_bf16_f32 v112, v80, v81
    v_mfma_f32_32x32x16_bf16 v[96:111], v[132:135], v[228:231], v[96:111]
    ds_read_b64_tr_b16 v[164:165], v9 offset:0
    ds_read_b64_tr_b16 v[166:167], v9 offset:2048
    v_exp_f32 v82, v82
    v_exp_f32 v83, v83
    v_add_f32 v220, v220, v82
    v_add_f32 v221, v221, v83
    v_cvt_pk_bf16_f32 v113, v82, v83
    s_waitcnt lgkmcnt(8)
    v_mfma_f32_32x32x16_bf16 v[96:111], v[136:139], v[232:235], v[96:111]
    ds_read_b64_tr_b16 v[168:169], v10 offset:0
    ds_read_b64_tr_b16 v[170:171], v10 offset:2048
    v_exp_f32 v84, v84
    v_exp_f32 v85, v85
    v_add_f32 v220, v220, v84
    v_add_f32 v221, v221, v85
    v_cvt_pk_bf16_f32 v114, v84, v85
    v_mfma_f32_32x32x16_bf16 v[96:111], v[140:143], v[236:239], v[96:111]
    ds_read_b64_tr_b16 v[172:173], v11 offset:0
    ds_read_b64_tr_b16 v[174:175], v11 offset:2048
    v_exp_f32 v86, v86
    v_exp_f32 v87, v87
    v_add_f32 v220, v220, v86
    v_add_f32 v221, v221, v87
    v_cvt_pk_bf16_f32 v115, v86, v87
    s_waitcnt lgkmcnt(10)
    v_mfma_f32_32x32x16_bf16 v[96:111], v[144:147], v[240:243], v[96:111]
    ds_read_b64_tr_b16 v[176:177], v8 offset:4096
    ds_read_b64_tr_b16 v[178:179], v8 offset:6144
    v_exp_f32 v88, v88
    v_exp_f32 v89, v89
    v_add_f32 v220, v220, v88
    v_add_f32 v221, v221, v89
    v_cvt_pk_bf16_f32 v116, v88, v89
    v_mfma_f32_32x32x16_bf16 v[96:111], v[148:151], v[244:247], v[96:111]
    ds_read_b64_tr_b16 v[180:181], v9 offset:4096
    ds_read_b64_tr_b16 v[182:183], v9 offset:6144
    v_exp_f32 v90, v90
    v_exp_f32 v91, v91
    v_add_f32 v220, v220, v90
    v_add_f32 v221, v221, v91
    v_cvt_pk_bf16_f32 v117, v90, v91
    s_waitcnt lgkmcnt(12)
    v_mfma_f32_32x32x16_bf16 v[96:111], v[152:155], v[248:251], v[96:111]
    ds_read_b64_tr_b16 v[184:185], v10 offset:4096
    ds_read_b64_tr_b16 v[186:187], v10 offset:6144
    v_exp_f32 v92, v92
    v_exp_f32 v93, v93
    v_add_f32 v220, v220, v92
    v_add_f32 v221, v221, v93
    v_cvt_pk_bf16_f32 v118, v92, v93
    v_mfma_f32_32x32x16_bf16 v[96:111], v[156:159], v[252:255], v[96:111]
    ds_read_b64_tr_b16 v[188:189], v11 offset:4096
    ds_read_b64_tr_b16 v[190:191], v11 offset:6144
    v_exp_f32 v94, v94
    v_exp_f32 v95, v95
    v_add_f32 v220, v220, v94
    v_add_f32 v221, v221, v95
    v_cvt_pk_bf16_f32 v119, v94, v95
    s_waitcnt lgkmcnt(12)
    v_mfma_f32_32x32x16_bf16 v[16:31], v[160:163], v[112:115], v[16:31]
    s_waitcnt vmcnt(8)
    s_barrier
    v_add_u32 v208, 32768, v208
    v_add_u32 v209, 32768, v209
    v_add_u32 v210, 32768, v210
    v_add_u32 v211, 32768, v211
    v_add_u32 v212, 32768, v212
    v_add_u32 v213, 32768, v213
    v_add_u32 v214, 32768, v214
    v_add_u32 v215, 32768, v215
    ds_read_b128 v[128:131], v208 offset:0
    v_mfma_f32_32x32x16_bf16 v[32:47], v[164:167], v[112:115], v[32:47]
    ds_read_b128 v[132:135], v209 offset:0
    s_add_u32 s92, s91, 7
    s_and_b32 s92, s92, 7
    s_lshl_b32 s92, s92, 14
    s_add_u32 s92, s92, s52
    s_add_u32 m0, s52, 0
    s_add_u32 s61, s92, 0
    buffer_load_dwordx4 v5, s[32:35], s61 offen lds
    s_waitcnt lgkmcnt(10)
    v_mfma_f32_32x32x16_bf16 v[48:63], v[168:171], v[112:115], v[48:63]
    ds_read_b128 v[136:139], v210 offset:0
    v_mfma_f32_32x32x16_bf16 v[64:79], v[172:175], v[112:115], v[64:79]
    ds_read_b128 v[140:143], v211 offset:0
    v_max3_f32 v216, v96, v97, v98
    v_max3_f32 v216, v99, v100, v216
    s_waitcnt lgkmcnt(8)
    v_mfma_f32_32x32x16_bf16 v[16:31], v[176:179], v[116:119], v[16:31]
    ds_read_b128 v[144:147], v212 offset:0
    v_max3_f32 v216, v101, v102, v216
    v_max3_f32 v216, v103, v104, v216
    v_mfma_f32_32x32x16_bf16 v[32:47], v[180:183], v[116:119], v[32:47]
    ds_read_b128 v[148:151], v213 offset:0
    s_add_u32 m0, s52, 8192
    s_add_u32 s61, s92, 8192
    buffer_load_dwordx4 v5, s[32:35], s61 offen lds
    v_max3_f32 v216, v105, v106, v216
    v_max3_f32 v216, v107, v108, v216
    s_waitcnt lgkmcnt(6)
    v_mfma_f32_32x32x16_bf16 v[48:63], v[184:187], v[116:119], v[48:63]
    ds_read_b128 v[152:155], v214 offset:0
    v_max3_f32 v216, v109, v110, v216
    v_max_f32 v216, v111, v216
    v_mfma_f32_32x32x16_bf16 v[64:79], v[188:191], v[116:119], v[64:79]
    ds_read_b128 v[156:159], v215 offset:0
    v_cmp_lt_f32 vcc, 0x41800000, v216
    s_nop 4
    s_cbranch_vccnz L_at_rare7
L_at_back7:
    s_waitcnt lgkmcnt(6)
    v_mfma_f32_32x32x16_bf16 v[80:95], v[128:131], v[224:227], v[192:207]
    ds_read_b64_tr_b16 v[160:161], v8 offset:8192
    ds_read_b64_tr_b16 v[162:163], v8 offset:10240
    v_exp_f32 v96, v96
    v_exp_f32 v97, v97
    v_add_f32 v220, v220, v96
    v_add_f32 v221, v221, v97
    v_cvt_pk_bf16_f32 v120, v96, v97
    v_mfma_f32_32x32x16_bf16 v[80:95], v[132:135], v[228:231], v[80:95]
    ds_read_b64_tr_b16 v[164:165], v9 offset:8192
    ds_read_b64_tr_b16 v[166:167], v9 offset:10240
    v_exp_f32 v98, v98
    v_exp_f32 v99, v99
    v_add_f32 v220, v220, v98
    v_add_f32 v221, v221, v99
    v_cvt_pk_bf16_f32 v121, v98, v99
    s_waitcnt lgkmcnt(8)
    v_mfma_f32_32x32x16_bf16 v[80:95], v[136:139], v[232:235], v[80:95]
    ds_read_b64_tr_b16 v[168:169], v10 offset:8192
    ds_read_b64_tr_b16 v[170:171], v10 offset:10240
    v_exp_f32 v100, v100
    v_exp_f32 v101, v101
    v_add_f32 v220, v220, v100
    v_add_f32 v221, v221, v101
    v_cvt_pk_bf16_f32 v122, v100, v101
    v_mfma_f32_32x32x16_bf16 v[80:95], v[140:143], v[236:239], v[80:95]
    ds_read_b64_tr_b16 v[172:173], v11 offset:8192
    ds_read_b64_tr_b16 v[174:175], v11 offset:10240
    v_exp_f32 v102, v102
    v_exp_f32 v103, v103
    v_add_f32 v220, v220, v102
    v_add_f32 v221, v221, v103
    v_cvt_pk_bf16_f32 v123, v102, v103
    s_waitcnt lgkmcnt(10)
    v_mfma_f32_32x32x16_bf16 v[80:95], v[144:147], v[240:243], v[80:95]
    ds_read_b64_tr_b16 v[176:177], v8 offset:12288
    ds_read_b64_tr_b16 v[178:179], v8 offset:14336
    v_exp_f32 v104, v104
    v_exp_f32 v105, v105
    v_add_f32 v220, v220, v104
    v_add_f32 v221, v221, v105
    v_cvt_pk_bf16_f32 v124, v104, v105
    v_mfma_f32_32x32x16_bf16 v[80:95], v[148:151], v[244:247], v[80:95]
    ds_read_b64_tr_b16 v[180:181], v9 offset:12288
    ds_read_b64_tr_b16 v[182:183], v9 offset:14336
    v_exp_f32 v106, v106
    v_exp_f32 v107, v107
    v_add_f32 v220, v220, v106
    v_add_f32 v221, v221, v107
    v_cvt_pk_bf16_f32 v125, v106, v107
    s_waitcnt lgkmcnt(12)
    v_mfma_f32_32x32x16_bf16 v[80:95], v[152:155], v[248:251], v[80:95]
    ds_read_b64_tr_b16 v[184:185], v10 offset:12288
    ds_read_b64_tr_b16 v[186:187], v10 offset:14336
    v_exp_f32 v108, v108
    v_exp_f32 v109, v109
    v_add_f32 v220, v220, v108
    v_add_f32 v221, v221, v109
    v_cvt_pk_bf16_f32 v126, v108, v109
    v_mfma_f32_32x32x16_bf16 v[80:95], v[156:159], v[252:255], v[80:95]
    ds_read_b64_tr_b16 v[188:189], v11 offset:12288
    ds_read_b64_tr_b16 v[190:191], v11 offset:14336
    v_exp_f32 v110, v110
    v_exp_f32 v111, v111
    v_add_f32 v220, v220, v110
    v_add_f32 v221, v221, v111
    v_cvt_pk_bf16_f32 v127, v110, v111
    s_waitcnt lgkmcnt(12)
    v_mfma_f32_32x32x16_bf16 v[16:31], v[160:163], v[120:123], v[16:31]
    ds_read_b128 v[128:131], v208 offset:8192
    v_mfma_f32_32x32x16_bf16 v[32:47], v[164:167], v[120:123], v[32:47]
    ds_read_b128 v[132:135], v209 offset:8192
    s_add_u32 m0, s52, 16384
    s_add_u32 s61, s92, 0
    buffer_load_dwordx4 v6, s[36:39], s61 offen lds
    s_waitcnt lgkmcnt(10)
    v_mfma_f32_32x32x16_bf16 v[48:63], v[168:171], v[120:123], v[48:63]
    ds_read_b128 v[136:139], v210 offset:8192
    v_mfma_f32_32x32x16_bf16 v[64:79], v[172:175], v[120:123], v[64:79]
    ds_read_b128 v[140:143], v211 offset:8192
    v_max3_f32 v216, v80, v81, v82
    v_max3_f32 v216, v83, v84, v216
    s_waitcnt lgkmcnt(8)
    v_mfma_f32_32x32x16_bf16 v[16:31], v[176:179], v[124:127], v[16:31]
    ds_read_b128 v[144:147], v212 offset:8192
    v_max3_f32 v216, v85, v86, v216
    v_max3_f32 v216, v87, v88, v216
    v_mfma_f32_32x32x16_bf16 v[32:47], v[180:183], v[124:127], v[32:47]
    ds_read_b128 v[148:151], v213 offset:8192
    s_add_u32 m0, s52, 24576
    s_add_u32 s61, s92, 8192
    buffer_load_dwordx4 v6, s[36:39], s61 offen lds
    v_max3_f32 v216, v89, v90, v216
    v_max3_f32 v216, v91, v92, v216
    s_waitcnt lgkmcnt(6)
    v_mfma_f32_32x32x16_bf16 v[48:63], v[184:187], v[124:127], v[48:63]
    ds_read_b128 v[152:155], v214 offset:8192
    v_max3_f32 v216, v93, v94, v216
    v_max_f32 v216, v95, v216
    v_mfma_f32_32x32x16_bf16 v[64:79], v[188:191], v[124:127], v[64:79]
    ds_read_b128 v[156:159], v215 offset:8192
    v_cmp_lt_f32 vcc, 0x41800000, v216
    s_nop 4
    s_cbranch_vccnz L_at_rare8
L_at_back8:
    s_waitcnt lgkmcnt(6)
    v_mfma_f32_32x32x16_bf16 v[96:111], v[128:131], v[224:227], v[192:207]
    v_add_u32 v8, 32768, v8
    v_add_u32 v9, 32768, v9
    v_add_u32 v10, 32768, v10
    v_add_u32 v11, 32768, v11
    ds_read_b64_tr_b16 v[160:161], v8 offset:0
    ds_read_b64_tr_b16 v[162:163], v8 offset:2048
    v_exp_f32 v80, v80
    v_exp_f32 v81, v81
    v_add_f32 v220, v220, v80
    v_add_f32 v221, v221, v81
    v_cvt_pk_bf16_f32 v112, v80, v81
    v_mfma_f32_32x32x16_bf16 v[96:111], v[132:135], v[228:231], v[96:111]
    ds_read_b64_tr_b16 v[164:165], v9 offset:0
    ds_read_b64_tr_b16 v[166:167], v9 offset:2048
    v_exp_f32 v82, v82
    v_exp_f32 v83, v83
    v_add_f32 v220, v220, v82
    v_add_f32 v221, v221, v83
    v_cvt_pk_bf16_f32 v113, v82, v83
    s_waitcnt lgkmcnt(8)
    v_mfma_f32_32x32x16_bf16 v[96:111], v[136:139], v[232:235], v[96:111]
    ds_read_b64_tr_b16 v[168:169], v10 offset:0
    ds_read_b64_tr_b16 v[170:171], v10 offset:2048
    v_exp_f32 v84, v84
    v_exp_f32 v85, v85
    v_add_f32 v220, v220, v84
    v_add_f32 v221, v221, v85
    v_cvt_pk_bf16_f32 v114, v84, v85
    v_mfma_f32_32x32x16_bf16 v[96:111], v[140:143], v[236:239], v[96:111]
    ds_read_b64_tr_b16 v[172:173], v11 offset:0
    ds_read_b64_tr_b16 v[174:175], v11 offset:2048
    v_exp_f32 v86, v86
    v_exp_f32 v87, v87
    v_add_f32 v220, v220, v86
    v_add_f32 v221, v221, v87
    v_cvt_pk_bf16_f32 v115, v86, v87
    s_waitcnt lgkmcnt(10)
    v_mfma_f32_32x32x16_bf16 v[96:111], v[144:147], v[240:243], v[96:111]
    ds_read_b64_tr_b16 v[176:177], v8 offset:4096
    ds_read_b64_tr_b16 v[178:179], v8 offset:6144
    v_exp_f32 v88, v88
    v_exp_f32 v89, v89
    v_add_f32 v220, v220, v88
    v_add_f32 v221, v221, v89
    v_cvt_pk_bf16_f32 v116, v88, v89
    v_mfma_f32_32x32x16_bf16 v[96:111], v[148:151], v[244:247], v[96:111]
    ds_read_b64_tr_b16 v[180:181], v9 offset:4096
    ds_read_b64_tr_b16 v[182:183], v9 offset:6144
    v_exp_f32 v90, v90
    v_exp_f32 v91, v91
    v_add_f32 v220, v220, v90
    v_add_f32 v221, v221, v91
    v_cvt_pk_bf16_f32 v117, v90, v91
    s_waitcnt lgkmcnt(12)
    v_mfma_f32_32x32x16_bf16 v[96:111], v[152:155], v[248:251], v[96:111]
    ds_read_b64_tr_b16 v[184:185], v10 offset:4096
    ds_read_b64_tr_b16 v[186:187], v10 offset:6144
    v_exp_f32 v92, v92
    v_exp_f32 v93, v93
    v_add_f32 v220, v220, v92
    v_add_f32 v221, v221, v93
    v_cvt_pk_bf16_f32 v118, v92, v93
    v_mfma_f32_32x32x16_bf16 v[96:111], v[156:159], v[252:255], v[96:111]
    ds_read_b64_tr_b16 v[188:189], v11 offset:4096
    ds_read_b64_tr_b16 v[190:191], v11 offset:6144
    v_exp_f32 v94, v94
    v_exp_f32 v95, v95
    v_add_f32 v220, v220, v94
    v_add_f32 v221, v221, v95
    v_cvt_pk_bf16_f32 v119, v94, v95
    s_waitcnt lgkmcnt(12)
    v_mfma_f32_32x32x16_bf16 v[16:31], v[160:163], v[112:115], v[16:31]
    s_waitcnt vmcnt(8)
    s_barrier
    v_add_u32 v208, 32768, v208
    v_add_u32 v209, 32768, v209
    v_add_u32 v210, 32768, v210
    v_add_u32 v211, 32768, v211
    v_add_u32 v212, 32768, v212
    v_add_u32 v213, 32768, v213
    v_add_u32 v214, 32768, v214
    v_add_u32 v215, 32768, v215
    ds_read_b128 v[128:131], v208 offset:0
    v_mfma_f32_32x32x16_bf16 v[32:47], v[164:167], v[112:115], v[32:47]
    ds_read_b128 v[132:135], v209 offset:0
    v_lshlrev_b32 v7, 4, v1
    s_lshl_b32 s96, s48, 12
    s_add_u32 m0, s96, 32768
    s_add_u32 s61, s97, 0
    buffer_load_dwordx4 v7, s[4:7], s61 offen lds
    s_waitcnt lgkmcnt(10)
    v_mfma_f32_32x32x16_bf16 v[48:63], v[168:171], v[112:115], v[48:63]
    ds_read_b128 v[136:139], v210 offset:0
    v_mfma_f32_32x32x16_bf16 v[64:79], v[172:175], v[112:115], v[64:79]
    ds_read_b128 v[140:143], v211 offset:0
    v_max3_f32 v216, v96, v97, v98
    v_max3_f32 v216, v99, v100, v216
    s_waitcnt lgkmcnt(8)
    v_mfma_f32_32x32x16_bf16 v[16:31], v[176:179], v[116:119], v[16:31]
    ds_read_b128 v[144:147], v212 offset:0
    v_max3_f32 v216, v101, v102, v216
    v_max3_f32 v216, v103, v104, v216
    v_mfma_f32_32x32x16_bf16 v[32:47], v[180:183], v[116:119], v[32:47]
    ds_read_b128 v[148:151], v213 offset:0
    s_add_u32 m0, s96, 33792
    s_add_u32 s61, s97, 1024
    buffer_load_dwordx4 v7, s[4:7], s61 offen lds
    v_max3_f32 v216, v105, v106, v216
    v_max3_f32 v216, v107, v108, v216
    s_waitcnt lgkmcnt(6)
    v_mfma_f32_32x32x16_bf16 v[48:63], v[184:187], v[116:119], v[48:63]
    ds_read_b128 v[152:155], v214 offset:0
    v_max3_f32 v216, v109, v110, v216
    v_max_f32 v216, v111, v216
    v_mfma_f32_32x32x16_bf16 v[64:79], v[188:191], v[116:119], v[64:79]
    ds_read_b128 v[156:159], v215 offset:0
    v_cmp_lt_f32 vcc, 0x41800000, v216
    s_nop 4
    s_cbranch_vccnz L_at_rare9
L_at_back9:
    s_waitcnt lgkmcnt(6)
    v_mfma_f32_32x32x16_bf16 v[80:95], v[128:131], v[224:227], v[192:207]
    ds_read_b64_tr_b16 v[160:161], v8 offset:8192
    ds_read_b64_tr_b16 v[162:163], v8 offset:10240
    v_exp_f32 v96, v96
    v_exp_f32 v97, v97
    v_add_f32 v220, v220, v96
    v_add_f32 v221, v221, v97
    v_cvt_pk_bf16_f32 v120, v96, v97
    v_mfma_f32_32x32x16_bf16 v[80:95], v[132:135], v[228:231], v[80:95]
    ds_read_b64_tr_b16 v[164:165], v9 offset:8192
    ds_read_b64_tr_b16 v[166:167], v9 offset:10240
    v_exp_f32 v98, v98
    v_exp_f32 v99, v99
    v_add_f32 v220, v220, v98
    v_add_f32 v221, v221, v99
    v_cvt_pk_bf16_f32 v121, v98, v99
    s_waitcnt lgkmcnt(8)
    v_mfma_f32_32x32x16_bf16 v[80:95], v[136:139], v[232:235], v[80:95]
    ds_read_b64_tr_b16 v[168:169], v10 offset:8192
    ds_read_b64_tr_b16 v[170:171], v10 offset:10240
    v_exp_f32 v100, v100
    v_exp_f32 v101, v101
    v_add_f32 v220, v220, v100
    v_add_f32 v221, v221, v101
    v_cvt_pk_bf16_f32 v122, v100, v101
    v_mfma_f32_32x32x16_bf16 v[80:95], v[140:143], v[236:239], v[80:95]
    ds_read_b64_tr_b16 v[172:173], v11 offset:8192
    ds_read_b64_tr_b16 v[174:175], v11 offset:10240
    v_exp_f32 v102, v102
    v_exp_f32 v103, v103
    v_add_f32 v220, v220, v102
    v_add_f32 v221, v221, v103
    v_cvt_pk_bf16_f32 v123, v102, v103
    s_waitcnt lgkmcnt(10)
    v_mfma_f32_32x32x16_bf16 v[80:95], v[144:147], v[240:243], v[80:95]
    ds_read_b64_tr_b16 v[176:177], v8 offset:12288
    ds_read_b64_tr_b16 v[178:179], v8 offset:14336
    v_exp_f32 v104, v104
    v_exp_f32 v105, v105
    v_add_f32 v220, v220, v104
    v_add_f32 v221, v221, v105
    v_cvt_pk_bf16_f32 v124, v104, v105
    v_mfma_f32_32x32x16_bf16 v[80:95], v[148:151], v[244:247], v[80:95]
    ds_read_b64_tr_b16 v[180:181], v9 offset:12288
    ds_read_b64_tr_b16 v[182:183], v9 offset:14336
    v_exp_f32 v106, v106
    v_exp_f32 v107, v107
    v_add_f32 v220, v220, v106
    v_add_f32 v221, v221, v107
    v_cvt_pk_bf16_f32 v125, v106, v107
    s_waitcnt lgkmcnt(12)
    v_mfma_f32_32x32x16_bf16 v[80:95], v[152:155], v[248:251], v[80:95]
    ds_read_b64_tr_b16 v[184:185], v10 offset:12288
    ds_read_b64_tr_b16 v[186:187], v10 offset:14336
    v_exp_f32 v108, v108
    v_exp_f32 v109, v109
    v_add_f32 v220, v220, v108
    v_add_f32 v221, v221, v109
    v_cvt_pk_bf16_f32 v126, v108, v109
    v_mfma_f32_32x32x16_bf16 v[80:95], v[156:159], v[252:255], v[80:95]
    ds_read_b64_tr_b16 v[188:189], v11 offset:12288
    ds_read_b64_tr_b16 v[190:191], v11 offset:14336
    v_exp_f32 v110, v110
    v_exp_f32 v111, v111
    v_add_f32 v220, v220, v110
    v_add_f32 v221, v221, v111
    v_cvt_pk_bf16_f32 v127, v110, v111
    s_waitcnt lgkmcnt(12)
    v_mfma_f32_32x32x16_bf16 v[16:31], v[160:163], v[120:123], v[16:31]
    ds_read_b128 v[128:131], v208 offset:8192
    v_mfma_f32_32x32x16_bf16 v[32:47], v[164:167], v[120:123], v[32:47]
    ds_read_b128 v[132:135], v209 offset:8192
    s_add_u32 m0, s96, 34816
    s_add_u32 s61, s97, 2048
    buffer_load_dwordx4 v7, s[4:7], s61 offen lds
    s_waitcnt lgkmcnt(10)
    v_mfma_f32_32x32x16_bf16 v[48:63], v[168:171], v[120:123], v[48:63]
    ds_read_b128 v[136:139], v210 offset:8192
    v_mfma_f32_32x32x16_bf16 v[64:79], v[172:175], v[120:123], v[64:79]
    ds_read_b128 v[140:143], v211 offset:8192
    v_max3_f32 v216, v80, v81, v82
    v_max3_f32 v216, v83, v84, v216
    s_waitcnt lgkmcnt(8)
    v_mfma_f32_32x32x16_bf16 v[16:31], v[176:179], v[124:127], v[16:31]
    ds_read_b128 v[144:147], v212 offset:8192
    v_max3_f32 v216, v85, v86, v216
    v_max3_f32 v216, v87, v88, v216
    v_mfma_f32_32x32x16_bf16 v[32:47], v[180:183], v[124:127], v[32:47]
    ds_read_b128 v[148:151], v213 offset:8192
    s_add_u32 m0, s96, 35840
    s_add_u32 s61, s97, 3072
    buffer_load_dwordx4 v7, s[4:7], s61 offen lds
    v_max3_f32 v216, v89, v90, v216
    v_max3_f32 v216, v91, v92, v216
    s_waitcnt lgkmcnt(6)
    v_mfma_f32_32x32x16_bf16 v[48:63], v[184:187], v[124:127], v[48:63]
    ds_read_b128 v[152:155], v214 offset:8192
    v_max3_f32 v216, v93, v94, v216
    v_max_f32 v216, v95, v216
    v_mfma_f32_32x32x16_bf16 v[64:79], v[188:191], v[124:127], v[64:79]
    ds_read_b128 v[156:159], v215 offset:8192
    v_cmp_lt_f32 vcc, 0x41800000, v216
    s_nop 4
    s_cbranch_vccnz L_at_rare10
L_at_back10:
    s_waitcnt lgkmcnt(6)
    v_mfma_f32_32x32x16_bf16 v[96:111], v[128:131], v[224:227], v[192:207]
    v_add_u32 v8, 32768, v8
    v_add_u32 v9, 32768, v9
    v_add_u32 v10, 32768, v10
    v_add_u32 v11, 32768, v11
    ds_read_b64_tr_b16 v[160:161], v8 offset:0
    ds_read_b64_tr_b16 v[162:163], v8 offset:2048
    v_exp_f32 v80, v80
    v_exp_f32 v81, v81
    v_add_f32 v220, v220, v80
    v_add_f32 v221, v221, v81
    v_cvt_pk_bf16_f32 v112, v80, v81
    v_mfma_f32_32x32x16_bf16 v[96:111], v[132:135], v[228:231], v[96:111]
    ds_read_b64_tr_b16 v[164:165], v9 offset:0
    ds_read_b64_tr_b16 v[166:167], v9 offset:2048
    v_exp_f32 v82, v82
    v_exp_f32 v83, v83
    v_add_f32 v220, v220, v82
    v_add_f32 v221, v221, v83
    v_cvt_pk_bf16_f32 v113, v82, v83
    s_waitcnt lgkmcnt(8)
    v_mfma_f32_32x32x16_bf16 v[96:111], v[136:139], v[232:235], v[96:111]
    ds_read_b64_tr_b16 v[168:169], v10 offset:0
    ds_read_b64_tr_b16 v[170:171], v10 offset:2048
    v_exp_f32 v84, v84
    v_exp_f32 v85, v85
    v_add_f32 v220, v220, v84
    v_add_f32 v221, v221, v85
    v_cvt_pk_bf16_f32 v114, v84, v85
    v_mfma_f32_32x32x16_bf16 v[96:111], v[140:143], v[236:239], v[96:111]
    ds_read_b64_tr_b16 v[172:173], v11 offset:0
    ds_read_b64_tr_b16 v[174:175], v11 offset:2048
    v_exp_f32 v86, v86
    v_exp_f32 v87, v87
    v_add_f32 v220, v220, v86
    v_add_f32 v221, v221, v87
    v_cvt_pk_bf16_f32 v115, v86, v87
    s_waitcnt lgkmcnt(10)
    v_mfma_f32_32x32x16_bf16 v[96:111], v[144:147], v[240:243], v[96:111]
    ds_read_b64_tr_b16 v[176:177], v8 offset:4096
    ds_read_b64_tr_b16 v[178:179], v8 offset:6144
    v_exp_f32 v88, v88
    v_exp_f32 v89, v89
    v_add_f32 v220, v220, v88
    v_add_f32 v221, v221, v89
    v_cvt_pk_bf16_f32 v116, v88, v89
    v_mfma_f32_32x32x16_bf16 v[96:111], v[148:151], v[244:247], v[96:111]
    ds_read_b64_tr_b16 v[180:181], v9 offset:4096
    ds_read_b64_tr_b16 v[182:183], v9 offset:6144
    v_exp_f32 v90, v90
    v_exp_f32 v91, v91
    v_add_f32 v220, v220, v90
    v_add_f32 v221, v221, v91
    v_cvt_pk_bf16_f32 v117, v90, v91
    s_waitcnt lgkmcnt(12)
    v_mfma_f32_32x32x16_bf16 v[96:111], v[152:155], v[248:251], v[96:111]
    ds_read_b64_tr_b16 v[184:185], v10 offset:4096
    ds_read_b64_tr_b16 v[186:187], v10 offset:6144
    v_exp_f32 v92, v92
    v_exp_f32 v93, v93
    v_add_f32 v220, v220, v92
    v_add_f32 v221, v221, v93
    v_cvt_pk_bf16_f32 v118, v92, v93
    v_mfma_f32_32x32x16_bf16 v[96:111], v[156:159], v[252:255], v[96:111]
    ds_read_b64_tr_b16 v[188:189], v11 offset:4096
    ds_read_b64_tr_b16 v[190:191], v11 offset:6144
    v_exp_f32 v94, v94
    v_exp_f32 v95, v95
    v_add_f32 v220, v220, v94
    v_add_f32 v221, v221, v95
    v_cvt_pk_bf16_f32 v119, v94, v95
    s_waitcnt lgkmcnt(12)
    v_mfma_f32_32x32x16_bf16 v[16:31], v[160:163], v[112:115], v[16:31]
    s_add_u32 m0, s96, 32768
    s_add_u32 s61, s97, 4096
    buffer_load_dwordx4 v7, s[4:7], s61 offen lds
    s_add_u32 m0, s96, 33792
    s_add_u32 s61, s97, 5120
    buffer_load_dwordx4 v7, s[4:7], s61 offen lds
    s_waitcnt vmcnt(10)
    s_barrier
    v_add_u32 v208, 32768, v208
    v_add_u32 v209, 32768, v209
    v_add_u32 v210, 32768, v210
    v_add_u32 v211, 32768, v211
    v_add_u32 v212, 32768, v212
    v_add_u32 v213, 32768, v213
    v_add_u32 v214, 32768, v214
    v_add_u32 v215, 32768, v215
    ds_read_b128 v[128:131], v208 offset:0
    v_mfma_f32_32x32x16_bf16 v[32:47], v[164:167], v[112:115], v[32:47]
    ds_read_b128 v[132:135], v209 offset:0
    s_waitcnt lgkmcnt(10)
    v_mfma_f32_32x32x16_bf16 v[48:63], v[168:171], v[112:115], v[48:63]
    ds_read_b128 v[136:139], v210 offset:0
    v_mfma_f32_32x32x16_bf16 v[64:79], v[172:175], v[112:115], v[64:79]
    ds_read_b128 v[140:143], v211 offset:0
    v_max3_f32 v216, v96, v97, v98
    v_max3_f32 v216, v99, v100, v216
    s_waitcnt lgkmcnt(8)
    v_mfma_f32_32x32x16_bf16 v[16:31], v[176:179], v[116:119], v[16:31]
    ds_read_b128 v[144:147], v212 offset:0
    v_max3_f32 v216, v101, v102, v216
    v_max3_f32 v216, v103, v104, v216
    v_mfma_f32_32x32x16_bf16 v[32:47], v[180:183], v[116:119], v[32:47]
    ds_read_b128 v[148:151], v213 offset:0
    v_max3_f32 v216, v105, v106, v216
    v_max3_f32 v216, v107, v108, v216
    s_waitcnt lgkmcnt(6)
    v_mfma_f32_32x32x16_bf16 v[48:63], v[184:187], v[116:119], v[48:63]
    ds_read_b128 v[152:155], v214 offset:0
    v_max3_f32 v216, v109, v110, v216
    v_max_f32 v216, v111, v216
    v_mfma_f32_32x32x16_bf16 v[64:79], v[188:191], v[116:119], v[64:79]
    ds_read_b128 v[156:159], v215 offset:0
    v_cmp_lt_f32 vcc, 0x41800000, v216
    s_nop 4
    s_cbranch_vccnz L_at_rare11
L_at_back11:
    s_waitcnt lgkmcnt(6)
    v_mfma_f32_32x32x16_bf16 v[80:95], v[128:131], v[224:227], v[192:207]
    ds_read_b64_tr_b16 v[160:161], v8 offset:8192
    ds_read_b64_tr_b16 v[162:163], v8 offset:10240
    v_exp_f32 v96, v96
    v_exp_f32 v97, v97
    v_add_f32 v220, v220, v96
    v_add_f32 v221, v221, v97
    v_cvt_pk_bf16_f32 v120, v96, v97
    v_mfma_f32_32x32x16_bf16 v[80:95], v[132:135], v[228:231], v[80:95]
    ds_read_b64_tr_b16 v[164:165], v9 offset:8192
    ds_read_b64_tr_b16 v[166:167], v9 offset:10240
    v_exp_f32 v98, v98
    v_exp_f32 v99, v99
    v_add_f32 v220, v220, v98
    v_add_f32 v221, v221, v99
    v_cvt_pk_bf16_f32 v121, v98, v99
    s_waitcnt lgkmcnt(8)
    v_mfma_f32_32x32x16_bf16 v[80:95], v[136:139], v[232:235], v[80:95]
    ds_read_b64_tr_b16 v[168:169], v10 offset:8192
    ds_read_b64_tr_b16 v[170:171], v10 offset:10240
    v_exp_f32 v100, v100
    v_exp_f32 v101, v101
    v_add_f32 v220, v220, v100
    v_add_f32 v221, v221, v101
    v_cvt_pk_bf16_f32 v122, v100, v101
    v_mfma_f32_32x32x16_bf16 v[80:95], v[140:143], v[236:239], v[80:95]
    ds_read_b64_tr_b16 v[172:173], v11 offset:8192
    ds_read_b64_tr_b16 v[174:175], v11 offset:10240
    v_exp_f32 v102, v102
    v_exp_f32 v103, v103
    v_add_f32 v220, v220, v102
    v_add_f32 v221, v221, v103
    v_cvt_pk_bf16_f32 v123, v102, v103
    s_waitcnt lgkmcnt(10)
    v_mfma_f32_32x32x16_bf16 v[80:95], v[144:147], v[240:243], v[80:95]
    ds_read_b64_tr_b16 v[176:177], v8 offset:12288
    ds_read_b64_tr_b16 v[178:179], v8 offset:14336
    v_exp_f32 v104, v104
    v_exp_f32 v105, v105
    v_add_f32 v220, v220, v104
    v_add_f32 v221, v221, v105
    v_cvt_pk_bf16_f32 v124, v104, v105
    v_mfma_f32_32x32x16_bf16 v[80:95], v[148:151], v[244:247], v[80:95]
    ds_read_b64_tr_b16 v[180:181], v9 offset:12288
    ds_read_b64_tr_b16 v[182:183], v9 offset:14336
    v_exp_f32 v106, v106
    v_exp_f32 v107, v107
    v_add_f32 v220, v220, v106
    v_add_f32 v221, v221, v107
    v_cvt_pk_bf16_f32 v125, v106, v107
    s_waitcnt lgkmcnt(12)
    v_mfma_f32_32x32x16_bf16 v[80:95], v[152:155], v[248:251], v[80:95]
    ds_read_b64_tr_b16 v[184:185], v10 offset:12288
    ds_read_b64_tr_b16 v[186:187], v10 offset:14336
    v_exp_f32 v108, v108
    v_exp_f32 v109, v109
    v_add_f32 v220, v220, v108
    v_add_f32 v221, v221, v109
    v_cvt_pk_bf16_f32 v126, v108, v109
    v_mfma_f32_32x32x16_bf16 v[80:95], v[156:159], v[252:255], v[80:95]
    ds_read_b64_tr_b16 v[188:189], v11 offset:12288
    ds_read_b64_tr_b16 v[190:191], v11 offset:14336
    v_exp_f32 v110, v110
    v_exp_f32 v111, v111
    v_add_f32 v220, v220, v110
    v_add_f32 v221, v221, v111
    v_cvt_pk_bf16_f32 v127, v110, v111
    s_waitcnt lgkmcnt(12)
    v_mfma_f32_32x32x16_bf16 v[16:31], v[160:163], v[120:123], v[16:31]
    ds_read_b128 v[128:131], v208 offset:8192
    v_mfma_f32_32x32x16_bf16 v[32:47], v[164:167], v[120:123], v[32:47]
    ds_read_b128 v[132:135], v209 offset:8192
    s_waitcnt lgkmcnt(10)
    v_mfma_f32_32x32x16_bf16 v[48:63], v[168:171], v[120:123], v[48:63]
    ds_read_b128 v[136:139], v210 offset:8192
    v_mfma_f32_32x32x16_bf16 v[64:79], v[172:175], v[120:123], v[64:79]
    ds_read_b128 v[140:143], v211 offset:8192
    v_max3_f32 v216, v80, v81, v82
    v_max3_f32 v216, v83, v84, v216
    s_waitcnt lgkmcnt(8)
    v_mfma_f32_32x32x16_bf16 v[16:31], v[176:179], v[124:127], v[16:31]
    ds_read_b128 v[144:147], v212 offset:8192
    v_max3_f32 v216, v85, v86, v216
    v_max3_f32 v216, v87, v88, v216
    v_mfma_f32_32x32x16_bf16 v[32:47], v[180:183], v[124:127], v[32:47]
    ds_read_b128 v[148:151], v213 offset:8192
    v_max3_f32 v216, v89, v90, v216
    v_max3_f32 v216, v91, v92, v216
    s_waitcnt lgkmcnt(6)
    v_mfma_f32_32x32x16_bf16 v[48:63], v[184:187], v[124:127], v[48:63]
    ds_read_b128 v[152:155], v214 offset:8192
    v_max3_f32 v216, v93, v94, v216
    v_max_f32 v216, v95, v216
    v_mfma_f32_32x32x16_bf16 v[64:79], v[188:191], v[124:127], v[64:79]
    ds_read_b128 v[156:159], v215 offset:8192
    v_cmp_lt_f32 vcc, 0x41800000, v216
    s_nop 4
    s_cbranch_vccnz L_at_rare12
L_at_back12:
    s_waitcnt lgkmcnt(6)
    v_mfma_f32_32x32x16_bf16 v[96:111], v[128:131], v[224:227], v[192:207]
    v_add_u32 v8, 32768, v8
    v_add_u32 v9, 32768, v9
    v_add_u32 v10, 32768, v10
    v_add_u32 v11, 32768, v11
    ds_read_b64_tr_b16 v[160:161], v8 offset:0
    ds_read_b64_tr_b16 v[162:163], v8 offset:2048
    v_exp_f32 v80, v80
    v_exp_f32 v81, v81
    v_add_f32 v220, v220, v80
    v_add_f32 v221, v221, v81
    v_cvt_pk_bf16_f32 v112, v80, v81
    v_mfma_f32_32x32x16_bf16 v[96:111], v[132:135], v[228:231], v[96:111]
    ds_read_b64_tr_b16 v[164:165], v9 offset:0
    ds_read_b64_tr_b16 v[166:167], v9 offset:2048
    v_exp_f32 v82, v82
    v_exp_f32 v83, v83
    v_add_f32 v220, v220, v82
    v_add_f32 v221, v221, v83
    v_cvt_pk_bf16_f32 v113, v82, v83
    s_waitcnt lgkmcnt(8)
    v_mfma_f32_32x32x16_bf16 v[96:111], v[136:139], v[232:235], v[96:111]
    ds_read_b64_tr_b16 v[168:169], v10 offset:0
    ds_read_b64_tr_b16 v[170:171], v10 offset:2048
    v_exp_f32 v84, v84
    v_exp_f32 v85, v85
    v_add_f32 v220, v220, v84
    v_add_f32 v221, v221, v85
    v_cvt_pk_bf16_f32 v114, v84, v85
    v_mfma_f32_32x32x16_bf16 v[96:111], v[140:143], v[236:239], v[96:111]
    ds_read_b64_tr_b16 v[172:173], v11 offset:0
    ds_read_b64_tr_b16 v[174:175], v11 offset:2048
    v_exp_f32 v86, v86
    v_exp_f32 v87, v87
    v_add_f32 v220, v220, v86
    v_add_f32 v221, v221, v87
    v_cvt_pk_bf16_f32 v115, v86, v87
    s_waitcnt lgkmcnt(10)
    v_mfma_f32_32x32x16_bf16 v[96:111], v[144:147], v[240:243], v[96:111]
    ds_read_b64_tr_b16 v[176:177], v8 offset:4096
    ds_read_b64_tr_b16 v[178:179], v8 offset:6144
    v_exp_f32 v88, v88
    v_exp_f32 v89, v89
    v_add_f32 v220, v220, v88
    v_add_f32 v221, v221, v89
    v_cvt_pk_bf16_f32 v116, v88, v89
    v_mfma_f32_32x32x16_bf16 v[96:111], v[148:151], v[244:247], v[96:111]
    ds_read_b64_tr_b16 v[180:181], v9 offset:4096
    ds_read_b64_tr_b16 v[182:183], v9 offset:6144
    v_exp_f32 v90, v90
    v_exp_f32 v91, v91
    v_add_f32 v220, v220, v90
    v_add_f32 v221, v221, v91
    v_cvt_pk_bf16_f32 v117, v90, v91
    s_waitcnt lgkmcnt(12)
    v_mfma_f32_32x32x16_bf16 v[96:111], v[152:155], v[248:251], v[96:111]
    ds_read_b64_tr_b16 v[184:185], v10 offset:4096
    ds_read_b64_tr_b16 v[186:187], v10 offset:6144
    v_exp_f32 v92, v92
    v_exp_f32 v93, v93
    v_add_f32 v220, v220, v92
    v_add_f32 v221, v221, v93
    v_cvt_pk_bf16_f32 v118, v92, v93
    v_mfma_f32_32x32x16_bf16 v[96:111], v[156:159], v[252:255], v[96:111]
    ds_read_b64_tr_b16 v[188:189], v11 offset:4096
    ds_read_b64_tr_b16 v[190:191], v11 offset:6144
    v_exp_f32 v94, v94
    v_exp_f32 v95, v95
    v_add_f32 v220, v220, v94
    v_add_f32 v221, v221, v95
    v_cvt_pk_bf16_f32 v119, v94, v95
    s_waitcnt lgkmcnt(12)
    v_mfma_f32_32x32x16_bf16 v[16:31], v[160:163], v[112:115], v[16:31]
    s_waitcnt vmcnt(6)
    s_barrier
    v_add_u32 v208, 4294836224, v208
    v_add_u32 v209, 4294836224, v209
    v_add_u32 v210, 4294836224, v210
    v_add_u32 v211, 4294836224, v211
    v_add_u32 v212, 4294836224, v212
    v_add_u32 v213, 4294836224, v213
    v_add_u32 v214, 4294836224, v214
    v_add_u32 v215, 4294836224, v215
    ds_read_b128 v[128:131], v208 offset:0
    v_mfma_f32_32x32x16_bf16 v[32:47], v[164:167], v[112:115], v[32:47]
    ds_read_b128 v[132:135], v209 offset:0
    s_waitcnt lgkmcnt(10)
    v_mfma_f32_32x32x16_bf16 v[48:63], v[168:171], v[112:115], v[48:63]
    ds_read_b128 v[136:139], v210 offset:0
    v_mfma_f32_32x32x16_bf16 v[64:79], v[172:175], v[112:115], v[64:79]
    ds_read_b128 v[140:143], v211 offset:0
    v_max3_f32 v216, v96, v97, v98
    v_max3_f32 v216, v99, v100, v216
    s_waitcnt lgkmcnt(8)
    v_mfma_f32_32x32x16_bf16 v[16:31], v[176:179], v[116:119], v[16:31]
    ds_read_b128 v[144:147], v212 offset:0
    v_max3_f32 v216, v101, v102, v216
    v_max3_f32 v216, v103, v104, v216
    v_mfma_f32_32x32x16_bf16 v[32:47], v[180:183], v[116:119], v[32:47]
    ds_read_b128 v[148:151], v213 offset:0
    v_max3_f32 v216, v105, v106, v216
    v_max3_f32 v216, v107, v108, v216
    s_waitcnt lgkmcnt(6)
    v_mfma_f32_32x32x16_bf16 v[48:63], v[184:187], v[116:119], v[48:63]
    ds_read_b128 v[152:155], v214 offset:0
    v_max3_f32 v216, v109, v110, v216
    v_max_f32 v216, v111, v216
    v_mfma_f32_32x32x16_bf16 v[64:79], v[188:191], v[116:119], v[64:79]
    ds_read_b128 v[156:159], v215 offset:0
    v_cmp_lt_f32 vcc, 0x41800000, v216
    s_nop 4
    s_cbranch_vccnz L_at_rare13
L_at_back13:
    s_waitcnt lgkmcnt(6)
    v_mfma_f32_32x32x16_bf16 v[80:95], v[128:131], v[224:227], v[192:207]
    ds_read_b64_tr_b16 v[160:161], v8 offset:8192
    ds_read_b64_tr_b16 v[162:163], v8 offset:10240
    v_exp_f32 v96, v96
    v_exp_f32 v97, v97
    v_add_f32 v220, v220, v96
    v_add_f32 v221, v221, v97
    v_cvt_pk_bf16_f32 v120, v96, v97
    v_mfma_f32_32x32x16_bf16 v[80:95], v[132:135], v[228:231], v[80:95]
    ds_read_b64_tr_b16 v[164:165], v9 offset:8192
    ds_read_b64_tr_b16 v[166:167], v9 offset:10240
    v_exp_f32 v98, v98
    v_exp_f32 v99, v99
    v_add_f32 v220, v220, v98
    v_add_f32 v221, v221, v99
    v_cvt_pk_bf16_f32 v121, v98, v99
    s_waitcnt lgkmcnt(8)
    v_mfma_f32_32x32x16_bf16 v[80:95], v[136:139], v[232:235], v[80:95]
    ds_read_b64_tr_b16 v[168:169], v10 offset:8192
    ds_read_b64_tr_b16 v[170:171], v10 offset:10240
    v_exp_f32 v100, v100
    v_exp_f32 v101, v101
    v_add_f32 v220, v220, v100
    v_add_f32 v221, v221, v101
    v_cvt_pk_bf16_f32 v122, v100, v101
    v_mfma_f32_32x32x16_bf16 v[80:95], v[140:143], v[236:239], v[80:95]
    ds_read_b64_tr_b16 v[172:173], v11 offset:8192
    ds_read_b64_tr_b16 v[174:175], v11 offset:10240
    v_exp_f32 v102, v102
    v_exp_f32 v103, v103
    v_add_f32 v220, v220, v102
    v_add_f32 v221, v221, v103
    v_cvt_pk_bf16_f32 v123, v102, v103
    s_waitcnt lgkmcnt(10)
    v_mfma_f32_32x32x16_bf16 v[80:95], v[144:147], v[240:243], v[80:95]
    ds_read_b64_tr_b16 v[176:177], v8 offset:12288
    ds_read_b64_tr_b16 v[178:179], v8 offset:14336
    v_exp_f32 v104, v104
    v_exp_f32 v105, v105
    v_add_f32 v220, v220, v104
    v_add_f32 v221, v221, v105
    v_cvt_pk_bf16_f32 v124, v104, v105
    v_mfma_f32_32x32x16_bf16 v[80:95], v[148:151], v[244:247], v[80:95]
    ds_read_b64_tr_b16 v[180:181], v9 offset:12288
    ds_read_b64_tr_b16 v[182:183], v9 offset:14336
    v_exp_f32 v106, v106
    v_exp_f32 v107, v107
    v_add_f32 v220, v220, v106
    v_add_f32 v221, v221, v107
    v_cvt_pk_bf16_f32 v125, v106, v107
    s_waitcnt lgkmcnt(12)
    v_mfma_f32_32x32x16_bf16 v[80:95], v[152:155], v[248:251], v[80:95]
    ds_read_b64_tr_b16 v[184:185], v10 offset:12288
    ds_read_b64_tr_b16 v[186:187], v10 offset:14336
    v_exp_f32 v108, v108
    v_exp_f32 v109, v109
    v_add_f32 v220, v220, v108
    v_add_f32 v221, v221, v109
    v_cvt_pk_bf16_f32 v126, v108, v109
    v_mfma_f32_32x32x16_bf16 v[80:95], v[156:159], v[252:255], v[80:95]
    ds_read_b64_tr_b16 v[188:189], v11 offset:12288
    ds_read_b64_tr_b16 v[190:191], v11 offset:14336
    v_exp_f32 v110, v110
    v_exp_f32 v111, v111
    v_add_f32 v220, v220, v110
    v_add_f32 v221, v221, v111
    v_cvt_pk_bf16_f32 v127, v110, v111
    s_waitcnt lgkmcnt(12)
    v_mfma_f32_32x32x16_bf16 v[16:31], v[160:163], v[120:123], v[16:31]
    ds_read_b128 v[128:131], v208 offset:8192
    v_mfma_f32_32x32x16_bf16 v[32:47], v[164:167], v[120:123], v[32:47]
    ds_read_b128 v[132:135], v209 offset:8192
    s_waitcnt lgkmcnt(10)
    v_mfma_f32_32x32x16_bf16 v[48:63], v[168:171], v[120:123], v[48:63]
    ds_read_b128 v[136:139], v210 offset:8192
    v_mfma_f32_32x32x16_bf16 v[64:79], v[172:175], v[120:123], v[64:79]
    ds_read_b128 v[140:143], v211 offset:8192
    v_max3_f32 v216, v80, v81, v82
    v_max3_f32 v216, v83, v84, v216
    s_waitcnt lgkmcnt(8)
    v_mfma_f32_32x32x16_bf16 v[16:31], v[176:179], v[124:127], v[16:31]
    ds_read_b128 v[144:147], v212 offset:8192
    v_max3_f32 v216, v85, v86, v216
    v_max3_f32 v216, v87, v88, v216
    v_mfma_f32_32x32x16_bf16 v[32:47], v[180:183], v[124:127], v[32:47]
    ds_read_b128 v[148:151], v213 offset:8192
    v_max3_f32 v216, v89, v90, v216
    v_max3_f32 v216, v91, v92, v216
    s_waitcnt lgkmcnt(6)
    v_mfma_f32_32x32x16_bf16 v[48:63], v[184:187], v[124:127], v[48:63]
    ds_read_b128 v[152:155], v214 offset:8192
    v_max3_f32 v216, v93, v94, v216
    v_max_f32 v216, v95, v216
    v_mfma_f32_32x32x16_bf16 v[64:79], v[188:191], v[124:127], v[64:79]
    ds_read_b128 v[156:159], v215 offset:8192
    v_cmp_lt_f32 vcc, 0x41800000, v216
    s_nop 4
    s_cbranch_vccnz L_at_rare14
L_at_back14:
    s_waitcnt lgkmcnt(6)
    v_mfma_f32_32x32x16_bf16 v[96:111], v[128:131], v[224:227], v[192:207]
    v_add_u32 v8, 4294836224, v8
    v_add_u32 v9, 4294836224, v9
    v_add_u32 v10, 4294836224, v10
    v_add_u32 v11, 4294836224, v11
    ds_read_b64_tr_b16 v[160:161], v8 offset:0
    ds_read_b64_tr_b16 v[162:163], v8 offset:2048
    v_exp_f32 v80, v80
    v_exp_f32 v81, v81
    v_add_f32 v220, v220, v80
    v_add_f32 v221, v221, v81
    v_cvt_pk_bf16_f32 v112, v80, v81
    v_mfma_f32_32x32x16_bf16 v[96:111], v[132:135], v[228:231], v[96:111]
    ds_read_b64_tr_b16 v[164:165], v9 offset:0
    ds_read_b64_tr_b16 v[166:167], v9 offset:2048
    v_exp_f32 v82, v82
    v_exp_f32 v83, v83
    v_add_f32 v220, v220, v82
    v_add_f32 v221, v221, v83
    v_cvt_pk_bf16_f32 v113, v82, v83
    s_waitcnt lgkmcnt(8)
    v_mfma_f32_32x32x16_bf16 v[96:111], v[136:139], v[232:235], v[96:111]
    ds_read_b64_tr_b16 v[168:169], v10 offset:0
    ds_read_b64_tr_b16 v[170:171], v10 offset:2048
    v_exp_f32 v84, v84
    v_exp_f32 v85, v85
    v_add_f32 v220, v220, v84
    v_add_f32 v221, v221, v85
    v_cvt_pk_bf16_f32 v114, v84, v85
    v_mfma_f32_32x32x16_bf16 v[96:111], v[140:143], v[236:239], v[96:111]
    ds_read_b64_tr_b16 v[172:173], v11 offset:0
    ds_read_b64_tr_b16 v[174:175], v11 offset:2048
    v_exp_f32 v86, v86
    v_exp_f32 v87, v87
    v_add_f32 v220, v220, v86
    v_add_f32 v221, v221, v87
    v_cvt_pk_bf16_f32 v115, v86, v87
    s_waitcnt lgkmcnt(10)
    v_mfma_f32_32x32x16_bf16 v[96:111], v[144:147], v[240:243], v[96:111]
    ds_read_b64_tr_b16 v[176:177], v8 offset:4096
    ds_read_b64_tr_b16 v[178:179], v8 offset:6144
    v_exp_f32 v88, v88
    v_exp_f32 v89, v89
    v_add_f32 v220, v220, v88
    v_add_f32 v221, v221, v89
    v_cvt_pk_bf16_f32 v116, v88, v89
    v_mfma_f32_32x32x16_bf16 v[96:111], v[148:151], v[244:247], v[96:111]
    ds_read_b64_tr_b16 v[180:181], v9 offset:4096
    ds_read_b64_tr_b16 v[182:183], v9 offset:6144
    v_exp_f32 v90, v90
    v_exp_f32 v91, v91
    v_add_f32 v220, v220, v90
    v_add_f32 v221, v221, v91
    v_cvt_pk_bf16_f32 v117, v90, v91
    s_waitcnt lgkmcnt(12)
    v_mfma_f32_32x32x16_bf16 v[96:111], v[152:155], v[248:251], v[96:111]
    ds_read_b64_tr_b16 v[184:185], v10 offset:4096
    ds_read_b64_tr_b16 v[186:187], v10 offset:6144
    v_exp_f32 v92, v92
    v_exp_f32 v93, v93
    v_add_f32 v220, v220, v92
    v_add_f32 v221, v221, v93
    v_cvt_pk_bf16_f32 v118, v92, v93
    v_mfma_f32_32x32x16_bf16 v[96:111], v[156:159], v[252:255], v[96:111]
    ds_read_b64_tr_b16 v[188:189], v11 offset:4096
    ds_read_b64_tr_b16 v[190:191], v11 offset:6144
    v_exp_f32 v94, v94
    v_exp_f32 v95, v95
    v_add_f32 v220, v220, v94
    v_add_f32 v221, v221, v95
    v_cvt_pk_bf16_f32 v119, v94, v95
    s_waitcnt lgkmcnt(12)
    v_mfma_f32_32x32x16_bf16 v[16:31], v[160:163], v[112:115], v[16:31]
    v_mfma_f32_32x32x16_bf16 v[32:47], v[164:167], v[112:115], v[32:47]
    s_waitcnt lgkmcnt(8)
    v_mfma_f32_32x32x16_bf16 v[48:63], v[168:171], v[112:115], v[48:63]
    v_mfma_f32_32x32x16_bf16 v[64:79], v[172:175], v[112:115], v[64:79]
    v_max3_f32 v216, v96, v97, v98
    v_max3_f32 v216, v99, v100, v216
    s_waitcnt lgkmcnt(4)
    v_mfma_f32_32x32x16_bf16 v[16:31], v[176:179], v[116:119], v[16:31]
    v_max3_f32 v216, v101, v102, v216
    v_max3_f32 v216, v103, v104, v216
    v_mfma_f32_32x32x16_bf16 v[32:47], v[180:183], v[116:119], v[32:47]
    v_max3_f32 v216, v105, v106, v216
    v_max3_f32 v216, v107, v108, v216
    s_waitcnt lgkmcnt(0)
    v_mfma_f32_32x32x16_bf16 v[48:63], v[184:187], v[116:119], v[48:63]
    v_max3_f32 v216, v109, v110, v216
    v_max_f32 v216, v111, v216
    v_mfma_f32_32x32x16_bf16 v[64:79], v[188:191], v[116:119], v[64:79]
    v_cmp_lt_f32 vcc, 0x41800000, v216
    s_nop 4
    s_cbranch_vccnz L_at_rare15
L_at_back15:
    ds_read_b64_tr_b16 v[160:161], v8 offset:8192
    ds_read_b64_tr_b16 v[162:163], v8 offset:10240
    v_exp_f32 v96, v96
    v_exp_f32 v97, v97
    v_add_f32 v220, v220, v96
    v_add_f32 v221, v221, v97
    v_cvt_pk_bf16_f32 v120, v96, v97
    ds_read_b64_tr_b16 v[164:165], v9 offset:8192
    ds_read_b64_tr_b16 v[166:167], v9 offset:10240
    v_exp_f32 v98, v98
    v_exp_f32 v99, v99
    v_add_f32 v220, v220, v98
    v_add_f32 v221, v221, v99
    v_cvt_pk_bf16_f32 v121, v98, v99
    ds_read_b64_tr_b16 v[168:169], v10 offset:8192
    ds_read_b64_tr_b16 v[170:171], v10 offset:10240
    v_exp_f32 v100, v100
    v_exp_f32 v101, v101
    v_add_f32 v220, v220, v100
    v_add_f32 v221, v221, v101
    v_cvt_pk_bf16_f32 v122, v100, v101
    ds_read_b64_tr_b16 v[172:173], v11 offset:8192
    ds_read_b64_tr_b16 v[174:175], v11 offset:10240
    v_exp_f32 v102, v102
    v_exp_f32 v103, v103
    v_add_f32 v220, v220, v102
    v_add_f32 v221, v221, v103
    v_cvt_pk_bf16_f32 v123, v102, v103
    ds_read_b64_tr_b16 v[176:177], v8 offset:12288
    ds_read_b64_tr_b16 v[178:179], v8 offset:14336
    v_exp_f32 v104, v104
    v_exp_f32 v105, v105
    v_add_f32 v220, v220, v104
    v_add_f32 v221, v221, v105
    v_cvt_pk_bf16_f32 v124, v104, v105
    ds_read_b64_tr_b16 v[180:181], v9 offset:12288
    ds_read_b64_tr_b16 v[182:183], v9 offset:14336
    v_exp_f32 v106, v106
    v_exp_f32 v107, v107
    v_add_f32 v220, v220, v106
    v_add_f32 v221, v221, v107
    v_cvt_pk_bf16_f32 v125, v106, v107
    ds_read_b64_tr_b16 v[184:185], v10 offset:12288
    ds_read_b64_tr_b16 v[186:187], v10 offset:14336
    v_exp_f32 v108, v108
    v_exp_f32 v109, v109
    v_add_f32 v220, v220, v108
    v_add_f32 v221, v221, v109
    v_cvt_pk_bf16_f32 v126, v108, v109
    ds_read_b64_tr_b16 v[188:189], v11 offset:12288
    ds_read_b64_tr_b16 v[190:191], v11 offset:14336
    v_exp_f32 v110, v110
    v_exp_f32 v111, v111
    v_add_f32 v220, v220, v110
    v_add_f32 v221, v221, v111
    v_cvt_pk_bf16_f32 v127, v110, v111
    s_waitcnt lgkmcnt(12)
    v_mfma_f32_32x32x16_bf16 v[16:31], v[160:163], v[120:123], v[16:31]
    v_mfma_f32_32x32x16_bf16 v[32:47], v[164:167], v[120:123], v[32:47]
    s_waitcnt lgkmcnt(8)
    v_mfma_f32_32x32x16_bf16 v[48:63], v[168:171], v[120:123], v[48:63]
    v_mfma_f32_32x32x16_bf16 v[64:79], v[172:175], v[120:123], v[64:79]
    s_waitcnt lgkmcnt(4)
    v_mfma_f32_32x32x16_bf16 v[16:31], v[176:179], v[124:127], v[16:31]
    v_mfma_f32_32x32x16_bf16 v[32:47], v[180:183], v[124:127], v[32:47]
    s_waitcnt lgkmcnt(0)
    v_mfma_f32_32x32x16_bf16 v[48:63], v[184:187], v[124:127], v[48:63]
    v_mfma_f32_32x32x16_bf16 v[64:79], v[188:191], v[124:127], v[64:79]
    v_add_f32 v220, v220, v221
    v_mov_b32 v221, v220
    s_nop 1
    v_permlane32_swap_b32 v220, v221
    v_add_f32 v220, v220, v221
    v_rcp_f32 v220, v220
    s_lshl_b32 s57, s48, 18
    v_lshl_add_u32 v15, v1, 4, s57
    s_mov_b32 s61, 4096
    v_mul_f32 v16, v16, v220
    v_mul_f32 v17, v17, v220
    v_mul_f32 v18, v18, v220
    v_mul_f32 v19, v19, v220
    v_mul_f32 v20, v20, v220
    v_mul_f32 v21, v21, v220
    v_mul_f32 v22, v22, v220
    v_mul_f32 v23, v23, v220
    v_cvt_pk_bf16_f32 v128, v16, v17
    v_cvt_pk_bf16_f32 v129, v18, v19
    v_cvt_pk_bf16_f32 v130, v20, v21
    v_cvt_pk_bf16_f32 v131, v22, v23
    buffer_store_dwordx4 v[128:131], v15, s[40:43], 0 offen offset:0 sc1
    v_mul_f32 v24, v24, v220
    v_mul_f32 v25, v25, v220
    v_mul_f32 v26, v26, v220
    v_mul_f32 v27, v27, v220
    v_mul_f32 v28, v28, v220
    v_mul_f32 v29, v29, v220
    v_mul_f32 v30, v30, v220
    v_mul_f32 v31, v31, v220
    v_cvt_pk_bf16_f32 v132, v24, v25
    v_cvt_pk_bf16_f32 v133, v26, v27
    v_cvt_pk_bf16_f32 v134, v28, v29
    v_cvt_pk_bf16_f32 v135, v30, v31
    buffer_store_dwordx4 v[132:135], v15, s[40:43], 0 offen offset:1024 sc1
    v_mul_f32 v32, v32, v220
    v_mul_f32 v33, v33, v220
    v_mul_f32 v34, v34, v220
    v_mul_f32 v35, v35, v220
    v_mul_f32 v36, v36, v220
    v_mul_f32 v37, v37, v220
    v_mul_f32 v38, v38, v220
    v_mul_f32 v39, v39, v220
    v_cvt_pk_bf16_f32 v136, v32, v33
    v_cvt_pk_bf16_f32 v137, v34, v35
    v_cvt_pk_bf16_f32 v138, v36, v37
    v_cvt_pk_bf16_f32 v139, v38, v39
    buffer_store_dwordx4 v[136:139], v15, s[40:43], 0 offen offset:2048 sc1
    v_mul_f32 v40, v40, v220
    v_mul_f32 v41, v41, v220
    v_mul_f32 v42, v42, v220
    v_mul_f32 v43, v43, v220
    v_mul_f32 v44, v44, v220
    v_mul_f32 v45, v45, v220
    v_mul_f32 v46, v46, v220
    v_mul_f32 v47, v47, v220
    v_cvt_pk_bf16_f32 v140, v40, v41
    v_cvt_pk_bf16_f32 v141, v42, v43
    v_cvt_pk_bf16_f32 v142, v44, v45
    v_cvt_pk_bf16_f32 v143, v46, v47
    buffer_store_dwordx4 v[140:143], v15, s[40:43], 0 offen offset:3072 sc1
    v_mul_f32 v48, v48, v220
    v_mul_f32 v49, v49, v220
    v_mul_f32 v50, v50, v220
    v_mul_f32 v51, v51, v220
    v_mul_f32 v52, v52, v220
    v_mul_f32 v53, v53, v220
    v_mul_f32 v54, v54, v220
    v_mul_f32 v55, v55, v220
    v_cvt_pk_bf16_f32 v144, v48, v49
    v_cvt_pk_bf16_f32 v145, v50, v51
    v_cvt_pk_bf16_f32 v146, v52, v53
    v_cvt_pk_bf16_f32 v147, v54, v55
    buffer_store_dwordx4 v[144:147], v15, s[40:43], s61 offen offset:0 sc1
    v_mul_f32 v56, v56, v220
    v_mul_f32 v57, v57, v220
    v_mul_f32 v58, v58, v220
    v_mul_f32 v59, v59, v220
    v_mul_f32 v60, v60, v220
    v_mul_f32 v61, v61, v220
    v_mul_f32 v62, v62, v220
    v_mul_f32 v63, v63, v220
    v_cvt_pk_bf16_f32 v148, v56, v57
    v_cvt_pk_bf16_f32 v149, v58, v59
    v_cvt_pk_bf16_f32 v150, v60, v61
    v_cvt_pk_bf16_f32 v151, v62, v63
    buffer_store_dwordx4 v[148:151], v15, s[40:43], s61 offen offset:1024 sc1
    v_mul_f32 v64, v64, v220
    v_mul_f32 v65, v65, v220
    v_mul_f32 v66, v66, v220
    v_mul_f32 v67, v67, v220
    v_mul_f32 v68, v68, v220
    v_mul_f32 v69, v69, v220
    v_mul_f32 v70, v70, v220
    v_mul_f32 v71, v71, v220
    v_cvt_pk_bf16_f32 v152, v64, v65
    v_cvt_pk_bf16_f32 v153, v66, v67
    v_cvt_pk_bf16_f32 v154, v68, v69
    v_cvt_pk_bf16_f32 v155, v70, v71
    buffer_store_dwordx4 v[152:155], v15, s[40:43], s61 offen offset:2048 sc1
    v_mul_f32 v72, v72, v220
    v_mul_f32 v73, v73, v220
    v_mul_f32 v74, v74, v220
    v_mul_f32 v75, v75, v220
    v_mul_f32 v76, v76, v220
    v_mul_f32 v77, v77, v220
    v_mul_f32 v78, v78, v220
    v_mul_f32 v79, v79, v220
    v_cvt_pk_bf16_f32 v156, v72, v73
    v_cvt_pk_bf16_f32 v157, v74, v75
    v_cvt_pk_bf16_f32 v158, v76, v77
    v_cvt_pk_bf16_f32 v159, v78, v79
    buffer_store_dwordx4 v[156:159], v15, s[40:43], s61 offen offset:3072 sc1
    s_branch L_at_end
L_at_rare1:
    s_nop 15
    v_mov_b32 v223, v216
    s_nop 1
    v_permlane32_swap_b32 v216, v223
    v_max_f32 v216, v216, v223
    v_max_f32 v216, 0, v216
    v_sub_f32 v96, v96, v216
    v_sub_f32 v97, v97, v216
    v_sub_f32 v98, v98, v216
    v_sub_f32 v99, v99, v216
    v_sub_f32 v100, v100, v216
    v_sub_f32 v101, v101, v216
    v_sub_f32 v102, v102, v216
    v_sub_f32 v103, v103, v216
    v_sub_f32 v104, v104, v216
    v_sub_f32 v105, v105, v216
    v_sub_f32 v106, v106, v216
    v_sub_f32 v107, v107, v216
    v_sub_f32 v108, v108, v216
    v_sub_f32 v109, v109, v216
    v_sub_f32 v110, v110, v216
    v_sub_f32 v111, v111, v216
    v_sub_f32 v192, v192, v216
    v_sub_f32 v193, v193, v216
    v_sub_f32 v194, v194, v216
    v_sub_f32 v195, v195, v216
    v_sub_f32 v196, v196, v216
    v_sub_f32 v197, v197, v216
    v_sub_f32 v198, v198, v216
    v_sub_f32 v199, v199, v216
    v_sub_f32 v200, v200, v216
    v_sub_f32 v201, v201, v216
    v_sub_f32 v202, v202, v216
    v_sub_f32 v203, v203, v216
    v_sub_f32 v204, v204, v216
    v_sub_f32 v205, v205, v216
    v_sub_f32 v206, v206, v216
    v_sub_f32 v207, v207, v216
    v_sub_f32 v222, 0, v216
    v_exp_f32 v222, v222
    s_nop 0
    v_mul_f32 v16, v16, v222
    v_mul_f32 v17, v17, v222
    v_mul_f32 v18, v18, v222
    v_mul_f32 v19, v19, v222
    v_mul_f32 v20, v20, v222
    v_mul_f32 v21, v21, v222
    v_mul_f32 v22, v22, v222
    v_mul_f32 v23, v23, v222
    v_mul_f32 v24, v24, v222
    v_mul_f32 v25, v25, v222
    v_mul_f32 v26, v26, v222
    v_mul_f32 v27, v27, v222
    v_mul_f32 v28, v28, v222
    v_mul_f32 v29, v29, v222
    v_mul_f32 v30, v30, v222
    v_mul_f32 v31, v31, v222
    v_mul_f32 v32, v32, v222
    v_mul_f32 v33, v33, v222
    v_mul_f32 v34, v34, v222
    v_mul_f32 v35, v35, v222
    v_mul_f32 v36, v36, v222
    v_mul_f32 v37, v37, v222
    v_mul_f32 v38, v38, v222
    v_mul_f32 v39, v39, v222
    v_mul_f32 v40, v40, v222
    v_mul_f32 v41, v41, v222
    v_mul_f32 v42, v42, v222
    v_mul_f32 v43, v43, v222
    v_mul_f32 v44, v44, v222
    v_mul_f32 v45, v45, v222
    v_mul_f32 v46, v46, v222
    v_mul_f32 v47, v47, v222
    v_mul_f32 v48, v48, v222
    v_mul_f32 v49, v49, v222
    v_mul_f32 v50, v50, v222
    v_mul_f32 v51, v51, v222
    v_mul_f32 v52, v52, v222
    v_mul_f32 v53, v53, v222
    v_mul_f32 v54, v54, v222
    v_mul_f32 v55, v55, v222
    v_mul_f32 v56, v56, v222
    v_mul_f32 v57, v57, v222
    v_mul_f32 v58, v58, v222
    v_mul_f32 v59, v59, v222
    v_mul_f32 v60, v60, v222
    v_mul_f32 v61, v61, v222
    v_mul_f32 v62, v62, v222
    v_mul_f32 v63, v63, v222
    v_mul_f32 v64, v64, v222
    v_mul_f32 v65, v65, v222
    v_mul_f32 v66, v66, v222
    v_mul_f32 v67, v67, v222
    v_mul_f32 v68, v68, v222
    v_mul_f32 v69, v69, v222
    v_mul_f32 v70, v70, v222
    v_mul_f32 v71, v71, v222
    v_mul_f32 v72, v72, v222
    v_mul_f32 v73, v73, v222
    v_mul_f32 v74, v74, v222
    v_mul_f32 v75, v75, v222
    v_mul_f32 v76, v76, v222
    v_mul_f32 v77, v77, v222
    v_mul_f32 v78, v78, v222
    v_mul_f32 v79, v79, v222
    v_mul_f32 v220, v220, v222
    v_mul_f32 v221, v221, v222
    s_nop 3
    s_branch L_at_back1
L_at_rare2:
    s_nop 15
    v_mov_b32 v223, v216
    s_nop 1
    v_permlane32_swap_b32 v216, v223
    v_max_f32 v216, v216, v223
    v_max_f32 v216, 0, v216
    v_sub_f32 v80, v80, v216
    v_sub_f32 v81, v81, v216
    v_sub_f32 v82, v82, v216
    v_sub_f32 v83, v83, v216
    v_sub_f32 v84, v84, v216
    v_sub_f32 v85, v85, v216
    v_sub_f32 v86, v86, v216
    v_sub_f32 v87, v87, v216
    v_sub_f32 v88, v88, v216
    v_sub_f32 v89, v89, v216
    v_sub_f32 v90, v90, v216
    v_sub_f32 v91, v91, v216
    v_sub_f32 v92, v92, v216
    v_sub_f32 v93, v93, v216
    v_sub_f32 v94, v94, v216
    v_sub_f32 v95, v95, v216
    v_sub_f32 v192, v192, v216
    v_sub_f32 v193, v193, v216
    v_sub_f32 v194, v194, v216
    v_sub_f32 v195, v195, v216
    v_sub_f32 v196, v196, v216
    v_sub_f32 v197, v197, v216
    v_sub_f32 v198, v198, v216
    v_sub_f32 v199, v199, v216
    v_sub_f32 v200, v200, v216
    v_sub_f32 v201, v201, v216
    v_sub_f32 v202, v202, v216
    v_sub_f32 v203, v203, v216
    v_sub_f32 v204, v204, v216
    v_sub_f32 v205, v205, v216
    v_sub_f32 v206, v206, v216
    v_sub_f32 v207, v207, v216
    v_sub_f32 v222, 0, v216
    v_exp_f32 v222, v222
    s_nop 0
    v_mul_f32 v16, v16, v222
    v_mul_f32 v17, v17, v222
    v_mul_f32 v18, v18, v222
    v_mul_f32 v19, v19, v222
    v_mul_f32 v20, v20, v222
    v_mul_f32 v21, v21, v222
    v_mul_f32 v22, v22, v222
    v_mul_f32 v23, v23, v222
    v_mul_f32 v24, v24, v222
    v_mul_f32 v25, v25, v222
    v_mul_f32 v26, v26, v222
    v_mul_f32 v27, v27, v222
    v_mul_f32 v28, v28, v222
    v_mul_f32 v29, v29, v222
    v_mul_f32 v30, v30, v222
    v_mul_f32 v31, v31, v222
    v_mul_f32 v32, v32, v222
    v_mul_f32 v33, v33, v222
    v_mul_f32 v34, v34, v222
    v_mul_f32 v35, v35, v222
    v_mul_f32 v36, v36, v222
    v_mul_f32 v37, v37, v222
    v_mul_f32 v38, v38, v222
    v_mul_f32 v39, v39, v222
    v_mul_f32 v40, v40, v222
    v_mul_f32 v41, v41, v222
    v_mul_f32 v42, v42, v222
    v_mul_f32 v43, v43, v222
    v_mul_f32 v44, v44, v222
    v_mul_f32 v45, v45, v222
    v_mul_f32 v46, v46, v222
    v_mul_f32 v47, v47, v222
    v_mul_f32 v48, v48, v222
    v_mul_f32 v49, v49, v222
    v_mul_f32 v50, v50, v222
    v_mul_f32 v51, v51, v222
    v_mul_f32 v52, v52, v222
    v_mul_f32 v53, v53, v222
    v_mul_f32 v54, v54, v222
    v_mul_f32 v55, v55, v222
    v_mul_f32 v56, v56, v222
    v_mul_f32 v57, v57, v222
    v_mul_f32 v58, v58, v222
    v_mul_f32 v59, v59, v222
    v_mul_f32 v60, v60, v222
    v_mul_f32 v61, v61, v222
    v_mul_f32 v62, v62, v222
    v_mul_f32 v63, v63, v222
    v_mul_f32 v64, v64, v222
    v_mul_f32 v65, v65, v222
    v_mul_f32 v66, v66, v222
    v_mul_f32 v67, v67, v222
    v_mul_f32 v68, v68, v222
    v_mul_f32 v69, v69, v222
    v_mul_f32 v70, v70, v222
    v_mul_f32 v71, v71, v222
    v_mul_f32 v72, v72, v222
    v_mul_f32 v73, v73, v222
    v_mul_f32 v74, v74, v222
    v_mul_f32 v75, v75, v222
    v_mul_f32 v76, v76, v222
    v_mul_f32 v77, v77, v222
    v_mul_f32 v78, v78, v222
    v_mul_f32 v79, v79, v222
    v_mul_f32 v220, v220, v222
    v_mul_f32 v221, v221, v222
    s_nop 3
    s_branch L_at_back2
L_at_rare3:
    s_nop 15
    v_mov_b32 v223, v216
    s_nop 1
    v_permlane32_swap_b32 v216, v223
    v_max_f32 v216, v216, v223
    v_max_f32 v216, 0, v216
    v_sub_f32 v96, v96, v216
    v_sub_f32 v97, v97, v216
    v_sub_f32 v98, v98, v216
    v_sub_f32 v99, v99, v216
    v_sub_f32 v100, v100, v216
    v_sub_f32 v101, v101, v216
    v_sub_f32 v102, v102, v216
    v_sub_f32 v103, v103, v216
    v_sub_f32 v104, v104, v216
    v_sub_f32 v105, v105, v216
    v_sub_f32 v106, v106, v216
    v_sub_f32 v107, v107, v216
    v_sub_f32 v108, v108, v216
    v_sub_f32 v109, v109, v216
    v_sub_f32 v110, v110, v216
    v_sub_f32 v111, v111, v216
    v_sub_f32 v192, v192, v216
    v_sub_f32 v193, v193, v216
    v_sub_f32 v194, v194, v216
    v_sub_f32 v195, v195, v216
    v_sub_f32 v196, v196, v216
    v_sub_f32 v197, v197, v216
    v_sub_f32 v198, v198, v216
    v_sub_f32 v199, v199, v216
    v_sub_f32 v200, v200, v216
    v_sub_f32 v201, v201, v216
    v_sub_f32 v202, v202, v216
    v_sub_f32 v203, v203, v216
    v_sub_f32 v204, v204, v216
    v_sub_f32 v205, v205, v216
    v_sub_f32 v206, v206, v216
    v_sub_f32 v207, v207, v216
    v_sub_f32 v222, 0, v216
    v_exp_f32 v222, v222
    s_nop 0
    v_mul_f32 v16, v16, v222
    v_mul_f32 v17, v17, v222
    v_mul_f32 v18, v18, v222
    v_mul_f32 v19, v19, v222
    v_mul_f32 v20, v20, v222
    v_mul_f32 v21, v21, v222
    v_mul_f32 v22, v22, v222
    v_mul_f32 v23, v23, v222
    v_mul_f32 v24, v24, v222
    v_mul_f32 v25, v25, v222
    v_mul_f32 v26, v26, v222
    v_mul_f32 v27, v27, v222
    v_mul_f32 v28, v28, v222
    v_mul_f32 v29, v29, v222
    v_mul_f32 v30, v30, v222
    v_mul_f32 v31, v31, v222
    v_mul_f32 v32, v32, v222
    v_mul_f32 v33, v33, v222
    v_mul_f32 v34, v34, v222
    v_mul_f32 v35, v35, v222
    v_mul_f32 v36, v36, v222
    v_mul_f32 v37, v37, v222
    v_mul_f32 v38, v38, v222
    v_mul_f32 v39, v39, v222
    v_mul_f32 v40, v40, v222
    v_mul_f32 v41, v41, v222
    v_mul_f32 v42, v42, v222
    v_mul_f32 v43, v43, v222
    v_mul_f32 v44, v44, v222
    v_mul_f32 v45, v45, v222
    v_mul_f32 v46, v46, v222
    v_mul_f32 v47, v47, v222
    v_mul_f32 v48, v48, v222
    v_mul_f32 v49, v49, v222
    v_mul_f32 v50, v50, v222
    v_mul_f32 v51, v51, v222
    v_mul_f32 v52, v52, v222
    v_mul_f32 v53, v53, v222
    v_mul_f32 v54, v54, v222
    v_mul_f32 v55, v55, v222
    v_mul_f32 v56, v56, v222
    v_mul_f32 v57, v57, v222
    v_mul_f32 v58, v58, v222
    v_mul_f32 v59, v59, v222
    v_mul_f32 v60, v60, v222
    v_mul_f32 v61, v61, v222
    v_mul_f32 v62, v62, v222
    v_mul_f32 v63, v63, v222
    v_mul_f32 v64, v64, v222
    v_mul_f32 v65, v65, v222
    v_mul_f32 v66, v66, v222
    v_mul_f32 v67, v67, v222
    v_mul_f32 v68, v68, v222
    v_mul_f32 v69, v69, v222
    v_mul_f32 v70, v70, v222
    v_mul_f32 v71, v71, v222
    v_mul_f32 v72, v72, v222
    v_mul_f32 v73, v73, v222
    v_mul_f32 v74, v74, v222
    v_mul_f32 v75, v75, v222
    v_mul_f32 v76, v76, v222
    v_mul_f32 v77, v77, v222
    v_mul_f32 v78, v78, v222
    v_mul_f32 v79, v79, v222
    v_mul_f32 v220, v220, v222
    v_mul_f32 v221, v221, v222
    s_nop 3
    s_branch L_at_back3
L_at_rare4:
    s_nop 15
    v_mov_b32 v223, v216
    s_nop 1
    v_permlane32_swap_b32 v216, v223
    v_max_f32 v216, v216, v223
    v_max_f32 v216, 0, v216
    v_sub_f32 v80, v80, v216
    v_sub_f32 v81, v81, v216
    v_sub_f32 v82, v82, v216
    v_sub_f32 v83, v83, v216
    v_sub_f32 v84, v84, v216
    v_sub_f32 v85, v85, v216
    v_sub_f32 v86, v86, v216
    v_sub_f32 v87, v87, v216
    v_sub_f32 v88, v88, v216
    v_sub_f32 v89, v89, v216
    v_sub_f32 v90, v90, v216
    v_sub_f32 v91, v91, v216
    v_sub_f32 v92, v92, v216
    v_sub_f32 v93, v93, v216
    v_sub_f32 v94, v94, v216
    v_sub_f32 v95, v95, v216
    v_sub_f32 v192, v192, v216
    v_sub_f32 v193, v193, v216
    v_sub_f32 v194, v194, v216
    v_sub_f32 v195, v195, v216
    v_sub_f32 v196, v196, v216
    v_sub_f32 v197, v197, v216
    v_sub_f32 v198, v198, v216
    v_sub_f32 v199, v199, v216
    v_sub_f32 v200, v200, v216
    v_sub_f32 v201, v201, v216
    v_sub_f32 v202, v202, v216
    v_sub_f32 v203, v203, v216
    v_sub_f32 v204, v204, v216
    v_sub_f32 v205, v205, v216
    v_sub_f32 v206, v206, v216
    v_sub_f32 v207, v207, v216
    v_sub_f32 v222, 0, v216
    v_exp_f32 v222, v222
    s_nop 0
    v_mul_f32 v16, v16, v222
    v_mul_f32 v17, v17, v222
    v_mul_f32 v18, v18, v222
    v_mul_f32 v19, v19, v222
    v_mul_f32 v20, v20, v222
    v_mul_f32 v21, v21, v222
    v_mul_f32 v22, v22, v222
    v_mul_f32 v23, v23, v222
    v_mul_f32 v24, v24, v222
    v_mul_f32 v25, v25, v222
    v_mul_f32 v26, v26, v222
    v_mul_f32 v27, v27, v222
    v_mul_f32 v28, v28, v222
    v_mul_f32 v29, v29, v222
    v_mul_f32 v30, v30, v222
    v_mul_f32 v31, v31, v222
    v_mul_f32 v32, v32, v222
    v_mul_f32 v33, v33, v222
    v_mul_f32 v34, v34, v222
    v_mul_f32 v35, v35, v222
    v_mul_f32 v36, v36, v222
    v_mul_f32 v37, v37, v222
    v_mul_f32 v38, v38, v222
    v_mul_f32 v39, v39, v222
    v_mul_f32 v40, v40, v222
    v_mul_f32 v41, v41, v222
    v_mul_f32 v42, v42, v222
    v_mul_f32 v43, v43, v222
    v_mul_f32 v44, v44, v222
    v_mul_f32 v45, v45, v222
    v_mul_f32 v46, v46, v222
    v_mul_f32 v47, v47, v222
    v_mul_f32 v48, v48, v222
    v_mul_f32 v49, v49, v222
    v_mul_f32 v50, v50, v222
    v_mul_f32 v51, v51, v222
    v_mul_f32 v52, v52, v222
    v_mul_f32 v53, v53, v222
    v_mul_f32 v54, v54, v222
    v_mul_f32 v55, v55, v222
    v_mul_f32 v56, v56, v222
    v_mul_f32 v57, v57, v222
    v_mul_f32 v58, v58, v222
    v_mul_f32 v59, v59, v222
    v_mul_f32 v60, v60, v222
    v_mul_f32 v61, v61, v222
    v_mul_f32 v62, v62, v222
    v_mul_f32 v63, v63, v222
    v_mul_f32 v64, v64, v222
    v_mul_f32 v65, v65, v222
    v_mul_f32 v66, v66, v222
    v_mul_f32 v67, v67, v222
    v_mul_f32 v68, v68, v222
    v_mul_f32 v69, v69, v222
    v_mul_f32 v70, v70, v222
    v_mul_f32 v71, v71, v222
    v_mul_f32 v72, v72, v222
    v_mul_f32 v73, v73, v222
    v_mul_f32 v74, v74, v222
    v_mul_f32 v75, v75, v222
    v_mul_f32 v76, v76, v222
    v_mul_f32 v77, v77, v222
    v_mul_f32 v78, v78, v222
    v_mul_f32 v79, v79, v222
    v_mul_f32 v220, v220, v222
    v_mul_f32 v221, v221, v222
    s_nop 3
    s_branch L_at_back4
L_at_rare5:
    s_nop 15
    v_mov_b32 v223, v216
    s_nop 1
    v_permlane32_swap_b32 v216, v223
    v_max_f32 v216, v216, v223
    v_max_f32 v216, 0, v216
    v_sub_f32 v96, v96, v216
    v_sub_f32 v97, v97, v216
    v_sub_f32 v98, v98, v216
    v_sub_f32 v99, v99, v216
    v_sub_f32 v100, v100, v216
    v_sub_f32 v101, v101, v216
    v_sub_f32 v102, v102, v216
    v_sub_f32 v103, v103, v216
    v_sub_f32 v104, v104, v216
    v_sub_f32 v105, v105, v216
    v_sub_f32 v106, v106, v216
    v_sub_f32 v107, v107, v216
    v_sub_f32 v108, v108, v216
    v_sub_f32 v109, v109, v216
    v_sub_f32 v110, v110, v216
    v_sub_f32 v111, v111, v216
    v_sub_f32 v192, v192, v216
    v_sub_f32 v193, v193, v216
    v_sub_f32 v194, v194, v216
    v_sub_f32 v195, v195, v216
    v_sub_f32 v196, v196, v216
    v_sub_f32 v197, v197, v216
    v_sub_f32 v198, v198, v216
    v_sub_f32 v199, v199, v216
    v_sub_f32 v200, v200, v216
    v_sub_f32 v201, v201, v216
    v_sub_f32 v202, v202, v216
    v_sub_f32 v203, v203, v216
    v_sub_f32 v204, v204, v216
    v_sub_f32 v205, v205, v216
    v_sub_f32 v206, v206, v216
    v_sub_f32 v207, v207, v216
    v_sub_f32 v222, 0, v216
    v_exp_f32 v222, v222
    s_nop 0
    v_mul_f32 v16, v16, v222
    v_mul_f32 v17, v17, v222
    v_mul_f32 v18, v18, v222
    v_mul_f32 v19, v19, v222
    v_mul_f32 v20, v20, v222
    v_mul_f32 v21, v21, v222
    v_mul_f32 v22, v22, v222
    v_mul_f32 v23, v23, v222
    v_mul_f32 v24, v24, v222
    v_mul_f32 v25, v25, v222
    v_mul_f32 v26, v26, v222
    v_mul_f32 v27, v27, v222
    v_mul_f32 v28, v28, v222
    v_mul_f32 v29, v29, v222
    v_mul_f32 v30, v30, v222
    v_mul_f32 v31, v31, v222
    v_mul_f32 v32, v32, v222
    v_mul_f32 v33, v33, v222
    v_mul_f32 v34, v34, v222
    v_mul_f32 v35, v35, v222
    v_mul_f32 v36, v36, v222
    v_mul_f32 v37, v37, v222
    v_mul_f32 v38, v38, v222
    v_mul_f32 v39, v39, v222
    v_mul_f32 v40, v40, v222
    v_mul_f32 v41, v41, v222
    v_mul_f32 v42, v42, v222
    v_mul_f32 v43, v43, v222
    v_mul_f32 v44, v44, v222
    v_mul_f32 v45, v45, v222
    v_mul_f32 v46, v46, v222
    v_mul_f32 v47, v47, v222
    v_mul_f32 v48, v48, v222
    v_mul_f32 v49, v49, v222
    v_mul_f32 v50, v50, v222
    v_mul_f32 v51, v51, v222
    v_mul_f32 v52, v52, v222
    v_mul_f32 v53, v53, v222
    v_mul_f32 v54, v54, v222
    v_mul_f32 v55, v55, v222
    v_mul_f32 v56, v56, v222
    v_mul_f32 v57, v57, v222
    v_mul_f32 v58, v58, v222
    v_mul_f32 v59, v59, v222
    v_mul_f32 v60, v60, v222
    v_mul_f32 v61, v61, v222
    v_mul_f32 v62, v62, v222
    v_mul_f32 v63, v63, v222
    v_mul_f32 v64, v64, v222
    v_mul_f32 v65, v65, v222
    v_mul_f32 v66, v66, v222
    v_mul_f32 v67, v67, v222
    v_mul_f32 v68, v68, v222
    v_mul_f32 v69, v69, v222
    v_mul_f32 v70, v70, v222
    v_mul_f32 v71, v71, v222
    v_mul_f32 v72, v72, v222
    v_mul_f32 v73, v73, v222
    v_mul_f32 v74, v74, v222
    v_mul_f32 v75, v75, v222
    v_mul_f32 v76, v76, v222
    v_mul_f32 v77, v77, v222
    v_mul_f32 v78, v78, v222
    v_mul_f32 v79, v79, v222
    v_mul_f32 v220, v220, v222
    v_mul_f32 v221, v221, v222
    s_nop 3
    s_branch L_at_back5
L_at_rare6:
    s_nop 15
    v_mov_b32 v223, v216
    s_nop 1
    v_permlane32_swap_b32 v216, v223
    v_max_f32 v216, v216, v223
    v_max_f32 v216, 0, v216
    v_sub_f32 v80, v80, v216
    v_sub_f32 v81, v81, v216
    v_sub_f32 v82, v82, v216
    v_sub_f32 v83, v83, v216
    v_sub_f32 v84, v84, v216
    v_sub_f32 v85, v85, v216
    v_sub_f32 v86, v86, v216
    v_sub_f32 v87, v87, v216
    v_sub_f32 v88, v88, v216
    v_sub_f32 v89, v89, v216
    v_sub_f32 v90, v90, v216
    v_sub_f32 v91, v91, v216
    v_sub_f32 v92, v92, v216
    v_sub_f32 v93, v93, v216
    v_sub_f32 v94, v94, v216
    v_sub_f32 v95, v95, v216
    v_sub_f32 v192, v192, v216
    v_sub_f32 v193, v193, v216
    v_sub_f32 v194, v194, v216
    v_sub_f32 v195, v195, v216
    v_sub_f32 v196, v196, v216
    v_sub_f32 v197, v197, v216
    v_sub_f32 v198, v198, v216
    v_sub_f32 v199, v199, v216
    v_sub_f32 v200, v200, v216
    v_sub_f32 v201, v201, v216
    v_sub_f32 v202, v202, v216
    v_sub_f32 v203, v203, v216
    v_sub_f32 v204, v204, v216
    v_sub_f32 v205, v205, v216
    v_sub_f32 v206, v206, v216
    v_sub_f32 v207, v207, v216
    v_sub_f32 v222, 0, v216
    v_exp_f32 v222, v222
    s_nop 0
    v_mul_f32 v16, v16, v222
    v_mul_f32 v17, v17, v222
    v_mul_f32 v18, v18, v222
    v_mul_f32 v19, v19, v222
    v_mul_f32 v20, v20, v222
    v_mul_f32 v21, v21, v222
    v_mul_f32 v22, v22, v222
    v_mul_f32 v23, v23, v222
    v_mul_f32 v24, v24, v222
    v_mul_f32 v25, v25, v222
    v_mul_f32 v26, v26, v222
    v_mul_f32 v27, v27, v222
    v_mul_f32 v28, v28, v222
    v_mul_f32 v29, v29, v222
    v_mul_f32 v30, v30, v222
    v_mul_f32 v31, v31, v222
    v_mul_f32 v32, v32, v222
    v_mul_f32 v33, v33, v222
    v_mul_f32 v34, v34, v222
    v_mul_f32 v35, v35, v222
    v_mul_f32 v36, v36, v222
    v_mul_f32 v37, v37, v222
    v_mul_f32 v38, v38, v222
    v_mul_f32 v39, v39, v222
    v_mul_f32 v40, v40, v222
    v_mul_f32 v41, v41, v222
    v_mul_f32 v42, v42, v222
    v_mul_f32 v43, v43, v222
    v_mul_f32 v44, v44, v222
    v_mul_f32 v45, v45, v222
    v_mul_f32 v46, v46, v222
    v_mul_f32 v47, v47, v222
    v_mul_f32 v48, v48, v222
    v_mul_f32 v49, v49, v222
    v_mul_f32 v50, v50, v222
    v_mul_f32 v51, v51, v222
    v_mul_f32 v52, v52, v222
    v_mul_f32 v53, v53, v222
    v_mul_f32 v54, v54, v222
    v_mul_f32 v55, v55, v222
    v_mul_f32 v56, v56, v222
    v_mul_f32 v57, v57, v222
    v_mul_f32 v58, v58, v222
    v_mul_f32 v59, v59, v222
    v_mul_f32 v60, v60, v222
    v_mul_f32 v61, v61, v222
    v_mul_f32 v62, v62, v222
    v_mul_f32 v63, v63, v222
    v_mul_f32 v64, v64, v222
    v_mul_f32 v65, v65, v222
    v_mul_f32 v66, v66, v222
    v_mul_f32 v67, v67, v222
    v_mul_f32 v68, v68, v222
    v_mul_f32 v69, v69, v222
    v_mul_f32 v70, v70, v222
    v_mul_f32 v71, v71, v222
    v_mul_f32 v72, v72, v222
    v_mul_f32 v73, v73, v222
    v_mul_f32 v74, v74, v222
    v_mul_f32 v75, v75, v222
    v_mul_f32 v76, v76, v222
    v_mul_f32 v77, v77, v222
    v_mul_f32 v78, v78, v222
    v_mul_f32 v79, v79, v222
    v_mul_f32 v220, v220, v222
    v_mul_f32 v221, v221, v222
    s_nop 3
    s_branch L_at_back6
L_at_rare7:
    s_nop 15
    v_mov_b32 v223, v216
    s_nop 1
    v_permlane32_swap_b32 v216, v223
    v_max_f32 v216, v216, v223
    v_max_f32 v216, 0, v216
    v_sub_f32 v96, v96, v216
    v_sub_f32 v97, v97, v216
    v_sub_f32 v98, v98, v216
    v_sub_f32 v99, v99, v216
    v_sub_f32 v100, v100, v216
    v_sub_f32 v101, v101, v216
    v_sub_f32 v102, v102, v216
    v_sub_f32 v103, v103, v216
    v_sub_f32 v104, v104, v216
    v_sub_f32 v105, v105, v216
    v_sub_f32 v106, v106, v216
    v_sub_f32 v107, v107, v216
    v_sub_f32 v108, v108, v216
    v_sub_f32 v109, v109, v216
    v_sub_f32 v110, v110, v216
    v_sub_f32 v111, v111, v216
    v_sub_f32 v192, v192, v216
    v_sub_f32 v193, v193, v216
    v_sub_f32 v194, v194, v216
    v_sub_f32 v195, v195, v216
    v_sub_f32 v196, v196, v216
    v_sub_f32 v197, v197, v216
    v_sub_f32 v198, v198, v216
    v_sub_f32 v199, v199, v216
    v_sub_f32 v200, v200, v216
    v_sub_f32 v201, v201, v216
    v_sub_f32 v202, v202, v216
    v_sub_f32 v203, v203, v216
    v_sub_f32 v204, v204, v216
    v_sub_f32 v205, v205, v216
    v_sub_f32 v206, v206, v216
    v_sub_f32 v207, v207, v216
    v_sub_f32 v222, 0, v216
    v_exp_f32 v222, v222
    s_nop 0
    v_mul_f32 v16, v16, v222
    v_mul_f32 v17, v17, v222
    v_mul_f32 v18, v18, v222
    v_mul_f32 v19, v19, v222
    v_mul_f32 v20, v20, v222
    v_mul_f32 v21, v21, v222
    v_mul_f32 v22, v22, v222
    v_mul_f32 v23, v23, v222
    v_mul_f32 v24, v24, v222
    v_mul_f32 v25, v25, v222
    v_mul_f32 v26, v26, v222
    v_mul_f32 v27, v27, v222
    v_mul_f32 v28, v28, v222
    v_mul_f32 v29, v29, v222
    v_mul_f32 v30, v30, v222
    v_mul_f32 v31, v31, v222
    v_mul_f32 v32, v32, v222
    v_mul_f32 v33, v33, v222
    v_mul_f32 v34, v34, v222
    v_mul_f32 v35, v35, v222
    v_mul_f32 v36, v36, v222
    v_mul_f32 v37, v37, v222
    v_mul_f32 v38, v38, v222
    v_mul_f32 v39, v39, v222
    v_mul_f32 v40, v40, v222
    v_mul_f32 v41, v41, v222
    v_mul_f32 v42, v42, v222
    v_mul_f32 v43, v43, v222
    v_mul_f32 v44, v44, v222
    v_mul_f32 v45, v45, v222
    v_mul_f32 v46, v46, v222
    v_mul_f32 v47, v47, v222
    v_mul_f32 v48, v48, v222
    v_mul_f32 v49, v49, v222
    v_mul_f32 v50, v50, v222
    v_mul_f32 v51, v51, v222
    v_mul_f32 v52, v52, v222
    v_mul_f32 v53, v53, v222
    v_mul_f32 v54, v54, v222
    v_mul_f32 v55, v55, v222
    v_mul_f32 v56, v56, v222
    v_mul_f32 v57, v57, v222
    v_mul_f32 v58, v58, v222
    v_mul_f32 v59, v59, v222
    v_mul_f32 v60, v60, v222
    v_mul_f32 v61, v61, v222
    v_mul_f32 v62, v62, v222
    v_mul_f32 v63, v63, v222
    v_mul_f32 v64, v64, v222
    v_mul_f32 v65, v65, v222
    v_mul_f32 v66, v66, v222
    v_mul_f32 v67, v67, v222
    v_mul_f32 v68, v68, v222
    v_mul_f32 v69, v69, v222
    v_mul_f32 v70, v70, v222
    v_mul_f32 v71, v71, v222
    v_mul_f32 v72, v72, v222
    v_mul_f32 v73, v73, v222
    v_mul_f32 v74, v74, v222
    v_mul_f32 v75, v75, v222
    v_mul_f32 v76, v76, v222
    v_mul_f32 v77, v77, v222
    v_mul_f32 v78, v78, v222
    v_mul_f32 v79, v79, v222
    v_mul_f32 v220, v220, v222
    v_mul_f32 v221, v221, v222
    s_nop 3
    s_branch L_at_back7
L_at_rare8:
    s_nop 15
    v_mov_b32 v223, v216
    s_nop 1
    v_permlane32_swap_b32 v216, v223
    v_max_f32 v216, v216, v223
    v_max_f32 v216, 0, v216
    v_sub_f32 v80, v80, v216
    v_sub_f32 v81, v81, v216
    v_sub_f32 v82, v82, v216
    v_sub_f32 v83, v83, v216
    v_sub_f32 v84, v84, v216
    v_sub_f32 v85, v85, v216
    v_sub_f32 v86, v86, v216
    v_sub_f32 v87, v87, v216
    v_sub_f32 v88, v88, v216
    v_sub_f32 v89, v89, v216
    v_sub_f32 v90, v90, v216
    v_sub_f32 v91, v91, v216
    v_sub_f32 v92, v92, v216
    v_sub_f32 v93, v93, v216
    v_sub_f32 v94, v94, v216
    v_sub_f32 v95, v95, v216
    v_sub_f32 v192, v192, v216
    v_sub_f32 v193, v193, v216
    v_sub_f32 v194, v194, v216
    v_sub_f32 v195, v195, v216
    v_sub_f32 v196, v196, v216
    v_sub_f32 v197, v197, v216
    v_sub_f32 v198, v198, v216
    v_sub_f32 v199, v199, v216
    v_sub_f32 v200, v200, v216
    v_sub_f32 v201, v201, v216
    v_sub_f32 v202, v202, v216
    v_sub_f32 v203, v203, v216
    v_sub_f32 v204, v204, v216
    v_sub_f32 v205, v205, v216
    v_sub_f32 v206, v206, v216
    v_sub_f32 v207, v207, v216
    v_sub_f32 v222, 0, v216
    v_exp_f32 v222, v222
    s_nop 0
    v_mul_f32 v16, v16, v222
    v_mul_f32 v17, v17, v222
    v_mul_f32 v18, v18, v222
    v_mul_f32 v19, v19, v222
    v_mul_f32 v20, v20, v222
    v_mul_f32 v21, v21, v222
    v_mul_f32 v22, v22, v222
    v_mul_f32 v23, v23, v222
    v_mul_f32 v24, v24, v222
    v_mul_f32 v25, v25, v222
    v_mul_f32 v26, v26, v222
    v_mul_f32 v27, v27, v222
    v_mul_f32 v28, v28, v222
    v_mul_f32 v29, v29, v222
    v_mul_f32 v30, v30, v222
    v_mul_f32 v31, v31, v222
    v_mul_f32 v32, v32, v222
    v_mul_f32 v33, v33, v222
    v_mul_f32 v34, v34, v222
    v_mul_f32 v35, v35, v222
    v_mul_f32 v36, v36, v222
    v_mul_f32 v37, v37, v222
    v_mul_f32 v38, v38, v222
    v_mul_f32 v39, v39, v222
    v_mul_f32 v40, v40, v222
    v_mul_f32 v41, v41, v222
    v_mul_f32 v42, v42, v222
    v_mul_f32 v43, v43, v222
    v_mul_f32 v44, v44, v222
    v_mul_f32 v45, v45, v222
    v_mul_f32 v46, v46, v222
    v_mul_f32 v47, v47, v222
    v_mul_f32 v48, v48, v222
    v_mul_f32 v49, v49, v222
    v_mul_f32 v50, v50, v222
    v_mul_f32 v51, v51, v222
    v_mul_f32 v52, v52, v222
    v_mul_f32 v53, v53, v222
    v_mul_f32 v54, v54, v222
    v_mul_f32 v55, v55, v222
    v_mul_f32 v56, v56, v222
    v_mul_f32 v57, v57, v222
    v_mul_f32 v58, v58, v222
    v_mul_f32 v59, v59, v222
    v_mul_f32 v60, v60, v222
    v_mul_f32 v61, v61, v222
    v_mul_f32 v62, v62, v222
    v_mul_f32 v63, v63, v222
    v_mul_f32 v64, v64, v222
    v_mul_f32 v65, v65, v222
    v_mul_f32 v66, v66, v222
    v_mul_f32 v67, v67, v222
    v_mul_f32 v68, v68, v222
    v_mul_f32 v69, v69, v222
    v_mul_f32 v70, v70, v222
    v_mul_f32 v71, v71, v222
    v_mul_f32 v72, v72, v222
    v_mul_f32 v73, v73, v222
    v_mul_f32 v74, v74, v222
    v_mul_f32 v75, v75, v222
    v_mul_f32 v76, v76, v222
    v_mul_f32 v77, v77, v222
    v_mul_f32 v78, v78, v222
    v_mul_f32 v79, v79, v222
    v_mul_f32 v220, v220, v222
    v_mul_f32 v221, v221, v222
    s_nop 3
    s_branch L_at_back8
L_at_rare9:
    s_nop 15
    v_mov_b32 v223, v216
    s_nop 1
    v_permlane32_swap_b32 v216, v223
    v_max_f32 v216, v216, v223
    v_max_f32 v216, 0, v216
    v_sub_f32 v96, v96, v216
    v_sub_f32 v97, v97, v216
    v_sub_f32 v98, v98, v216
    v_sub_f32 v99, v99, v216
    v_sub_f32 v100, v100, v216
    v_sub_f32 v101, v101, v216
    v_sub_f32 v102, v102, v216
    v_sub_f32 v103, v103, v216
    v_sub_f32 v104, v104, v216
    v_sub_f32 v105, v105, v216
    v_sub_f32 v106, v106, v216
    v_sub_f32 v107, v107, v216
    v_sub_f32 v108, v108, v216
    v_sub_f32 v109, v109, v216
    v_sub_f32 v110, v110, v216
    v_sub_f32 v111, v111, v216
    v_sub_f32 v192, v192, v216
    v_sub_f32 v193, v193, v216
    v_sub_f32 v194, v194, v216
    v_sub_f32 v195, v195, v216
    v_sub_f32 v196, v196, v216
    v_sub_f32 v197, v197, v216
    v_sub_f32 v198, v198, v216
    v_sub_f32 v199, v199, v216
    v_sub_f32 v200, v200, v216
    v_sub_f32 v201, v201, v216
    v_sub_f32 v202, v202, v216
    v_sub_f32 v203, v203, v216
    v_sub_f32 v204, v204, v216
    v_sub_f32 v205, v205, v216
    v_sub_f32 v206, v206, v216
    v_sub_f32 v207, v207, v216
    v_sub_f32 v222, 0, v216
    v_exp_f32 v222, v222
    s_nop 0
    v_mul_f32 v16, v16, v222
    v_mul_f32 v17, v17, v222
    v_mul_f32 v18, v18, v222
    v_mul_f32 v19, v19, v222
    v_mul_f32 v20, v20, v222
    v_mul_f32 v21, v21, v222
    v_mul_f32 v22, v22, v222
    v_mul_f32 v23, v23, v222
    v_mul_f32 v24, v24, v222
    v_mul_f32 v25, v25, v222
    v_mul_f32 v26, v26, v222
    v_mul_f32 v27, v27, v222
    v_mul_f32 v28, v28, v222
    v_mul_f32 v29, v29, v222
    v_mul_f32 v30, v30, v222
    v_mul_f32 v31, v31, v222
    v_mul_f32 v32, v32, v222
    v_mul_f32 v33, v33, v222
    v_mul_f32 v34, v34, v222
    v_mul_f32 v35, v35, v222
    v_mul_f32 v36, v36, v222
    v_mul_f32 v37, v37, v222
    v_mul_f32 v38, v38, v222
    v_mul_f32 v39, v39, v222
    v_mul_f32 v40, v40, v222
    v_mul_f32 v41, v41, v222
    v_mul_f32 v42, v42, v222
    v_mul_f32 v43, v43, v222
    v_mul_f32 v44, v44, v222
    v_mul_f32 v45, v45, v222
    v_mul_f32 v46, v46, v222
    v_mul_f32 v47, v47, v222
    v_mul_f32 v48, v48, v222
    v_mul_f32 v49, v49, v222
    v_mul_f32 v50, v50, v222
    v_mul_f32 v51, v51, v222
    v_mul_f32 v52, v52, v222
    v_mul_f32 v53, v53, v222
    v_mul_f32 v54, v54, v222
    v_mul_f32 v55, v55, v222
    v_mul_f32 v56, v56, v222
    v_mul_f32 v57, v57, v222
    v_mul_f32 v58, v58, v222
    v_mul_f32 v59, v59, v222
    v_mul_f32 v60, v60, v222
    v_mul_f32 v61, v61, v222
    v_mul_f32 v62, v62, v222
    v_mul_f32 v63, v63, v222
    v_mul_f32 v64, v64, v222
    v_mul_f32 v65, v65, v222
    v_mul_f32 v66, v66, v222
    v_mul_f32 v67, v67, v222
    v_mul_f32 v68, v68, v222
    v_mul_f32 v69, v69, v222
    v_mul_f32 v70, v70, v222
    v_mul_f32 v71, v71, v222
    v_mul_f32 v72, v72, v222
    v_mul_f32 v73, v73, v222
    v_mul_f32 v74, v74, v222
    v_mul_f32 v75, v75, v222
    v_mul_f32 v76, v76, v222
    v_mul_f32 v77, v77, v222
    v_mul_f32 v78, v78, v222
    v_mul_f32 v79, v79, v222
    v_mul_f32 v220, v220, v222
    v_mul_f32 v221, v221, v222
    s_nop 3
    s_branch L_at_back9
L_at_rare10:
    s_nop 15
    v_mov_b32 v223, v216
    s_nop 1
    v_permlane32_swap_b32 v216, v223
    v_max_f32 v216, v216, v223
    v_max_f32 v216, 0, v216
    v_sub_f32 v80, v80, v216
    v_sub_f32 v81, v81, v216
    v_sub_f32 v82, v82, v216
    v_sub_f32 v83, v83, v216
    v_sub_f32 v84, v84, v216
    v_sub_f32 v85, v85, v216
    v_sub_f32 v86, v86, v216
    v_sub_f32 v87, v87, v216
    v_sub_f32 v88, v88, v216
    v_sub_f32 v89, v89, v216
    v_sub_f32 v90, v90, v216
    v_sub_f32 v91, v91, v216
    v_sub_f32 v92, v92, v216
    v_sub_f32 v93, v93, v216
    v_sub_f32 v94, v94, v216
    v_sub_f32 v95, v95, v216
    v_sub_f32 v192, v192, v216
    v_sub_f32 v193, v193, v216
    v_sub_f32 v194, v194, v216
    v_sub_f32 v195, v195, v216
    v_sub_f32 v196, v196, v216
    v_sub_f32 v197, v197, v216
    v_sub_f32 v198, v198, v216
    v_sub_f32 v199, v199, v216
    v_sub_f32 v200, v200, v216
    v_sub_f32 v201, v201, v216
    v_sub_f32 v202, v202, v216
    v_sub_f32 v203, v203, v216
    v_sub_f32 v204, v204, v216
    v_sub_f32 v205, v205, v216
    v_sub_f32 v206, v206, v216
    v_sub_f32 v207, v207, v216
    v_sub_f32 v222, 0, v216
    v_exp_f32 v222, v222
    s_nop 0
    v_mul_f32 v16, v16, v222
    v_mul_f32 v17, v17, v222
    v_mul_f32 v18, v18, v222
    v_mul_f32 v19, v19, v222
    v_mul_f32 v20, v20, v222
    v_mul_f32 v21, v21, v222
    v_mul_f32 v22, v22, v222
    v_mul_f32 v23, v23, v222
    v_mul_f32 v24, v24, v222
    v_mul_f32 v25, v25, v222
    v_mul_f32 v26, v26, v222
    v_mul_f32 v27, v27, v222
    v_mul_f32 v28, v28, v222
    v_mul_f32 v29, v29, v222
    v_mul_f32 v30, v30, v222
    v_mul_f32 v31, v31, v222
    v_mul_f32 v32, v32, v222
    v_mul_f32 v33, v33, v222
    v_mul_f32 v34, v34, v222
    v_mul_f32 v35, v35, v222
    v_mul_f32 v36, v36, v222
    v_mul_f32 v37, v37, v222
    v_mul_f32 v38, v38, v222
    v_mul_f32 v39, v39, v222
    v_mul_f32 v40, v40, v222
    v_mul_f32 v41, v41, v222
    v_mul_f32 v42, v42, v222
    v_mul_f32 v43, v43, v222
    v_mul_f32 v44, v44, v222
    v_mul_f32 v45, v45, v222
    v_mul_f32 v46, v46, v222
    v_mul_f32 v47, v47, v222
    v_mul_f32 v48, v48, v222
    v_mul_f32 v49, v49, v222
    v_mul_f32 v50, v50, v222
    v_mul_f32 v51, v51, v222
    v_mul_f32 v52, v52, v222
    v_mul_f32 v53, v53, v222
    v_mul_f32 v54, v54, v222
    v_mul_f32 v55, v55, v222
    v_mul_f32 v56, v56, v222
    v_mul_f32 v57, v57, v222
    v_mul_f32 v58, v58, v222
    v_mul_f32 v59, v59, v222
    v_mul_f32 v60, v60, v222
    v_mul_f32 v61, v61, v222
    v_mul_f32 v62, v62, v222
    v_mul_f32 v63, v63, v222
    v_mul_f32 v64, v64, v222
    v_mul_f32 v65, v65, v222
    v_mul_f32 v66, v66, v222
    v_mul_f32 v67, v67, v222
    v_mul_f32 v68, v68, v222
    v_mul_f32 v69, v69, v222
    v_mul_f32 v70, v70, v222
    v_mul_f32 v71, v71, v222
    v_mul_f32 v72, v72, v222
    v_mul_f32 v73, v73, v222
    v_mul_f32 v74, v74, v222
    v_mul_f32 v75, v75, v222
    v_mul_f32 v76, v76, v222
    v_mul_f32 v77, v77, v222
    v_mul_f32 v78, v78, v222
    v_mul_f32 v79, v79, v222
    v_mul_f32 v220, v220, v222
    v_mul_f32 v221, v221, v222
    s_nop 3
    s_branch L_at_back10
L_at_rare11:
    s_nop 15
    v_mov_b32 v223, v216
    s_nop 1
    v_permlane32_swap_b32 v216, v223
    v_max_f32 v216, v216, v223
    v_max_f32 v216, 0, v216
    v_sub_f32 v96, v96, v216
    v_sub_f32 v97, v97, v216
    v_sub_f32 v98, v98, v216
    v_sub_f32 v99, v99, v216
    v_sub_f32 v100, v100, v216
    v_sub_f32 v101, v101, v216
    v_sub_f32 v102, v102, v216
    v_sub_f32 v103, v103, v216
    v_sub_f32 v104, v104, v216
    v_sub_f32 v105, v105, v216
    v_sub_f32 v106, v106, v216
    v_sub_f32 v107, v107, v216
    v_sub_f32 v108, v108, v216
    v_sub_f32 v109, v109, v216
    v_sub_f32 v110, v110, v216
    v_sub_f32 v111, v111, v216
    v_sub_f32 v192, v192, v216
    v_sub_f32 v193, v193, v216
    v_sub_f32 v194, v194, v216
    v_sub_f32 v195, v195, v216
    v_sub_f32 v196, v196, v216
    v_sub_f32 v197, v197, v216
    v_sub_f32 v198, v198, v216
    v_sub_f32 v199, v199, v216
    v_sub_f32 v200, v200, v216
    v_sub_f32 v201, v201, v216
    v_sub_f32 v202, v202, v216
    v_sub_f32 v203, v203, v216
    v_sub_f32 v204, v204, v216
    v_sub_f32 v205, v205, v216
    v_sub_f32 v206, v206, v216
    v_sub_f32 v207, v207, v216
    v_sub_f32 v222, 0, v216
    v_exp_f32 v222, v222
    s_nop 0
    v_mul_f32 v16, v16, v222
    v_mul_f32 v17, v17, v222
    v_mul_f32 v18, v18, v222
    v_mul_f32 v19, v19, v222
    v_mul_f32 v20, v20, v222
    v_mul_f32 v21, v21, v222
    v_mul_f32 v22, v22, v222
    v_mul_f32 v23, v23, v222
    v_mul_f32 v24, v24, v222
    v_mul_f32 v25, v25, v222
    v_mul_f32 v26, v26, v222
    v_mul_f32 v27, v27, v222
    v_mul_f32 v28, v28, v222
    v_mul_f32 v29, v29, v222
    v_mul_f32 v30, v30, v222
    v_mul_f32 v31, v31, v222
    v_mul_f32 v32, v32, v222
    v_mul_f32 v33, v33, v222
    v_mul_f32 v34, v34, v222
    v_mul_f32 v35, v35, v222
    v_mul_f32 v36, v36, v222
    v_mul_f32 v37, v37, v222
    v_mul_f32 v38, v38, v222
    v_mul_f32 v39, v39, v222
    v_mul_f32 v40, v40, v222
    v_mul_f32 v41, v41, v222
    v_mul_f32 v42, v42, v222
    v_mul_f32 v43, v43, v222
    v_mul_f32 v44, v44, v222
    v_mul_f32 v45, v45, v222
    v_mul_f32 v46, v46, v222
    v_mul_f32 v47, v47, v222
    v_mul_f32 v48, v48, v222
    v_mul_f32 v49, v49, v222
    v_mul_f32 v50, v50, v222
    v_mul_f32 v51, v51, v222
    v_mul_f32 v52, v52, v222
    v_mul_f32 v53, v53, v222
    v_mul_f32 v54, v54, v222
    v_mul_f32 v55, v55, v222
    v_mul_f32 v56, v56, v222
    v_mul_f32 v57, v57, v222
    v_mul_f32 v58, v58, v222
    v_mul_f32 v59, v59, v222
    v_mul_f32 v60, v60, v222
    v_mul_f32 v61, v61, v222
    v_mul_f32 v62, v62, v222
    v_mul_f32 v63, v63, v222
    v_mul_f32 v64, v64, v222
    v_mul_f32 v65, v65, v222
    v_mul_f32 v66, v66, v222
    v_mul_f32 v67, v67, v222
    v_mul_f32 v68, v68, v222
    v_mul_f32 v69, v69, v222
    v_mul_f32 v70, v70, v222
    v_mul_f32 v71, v71, v222
    v_mul_f32 v72, v72, v222
    v_mul_f32 v73, v73, v222
    v_mul_f32 v74, v74, v222
    v_mul_f32 v75, v75, v222
    v_mul_f32 v76, v76, v222
    v_mul_f32 v77, v77, v222
    v_mul_f32 v78, v78, v222
    v_mul_f32 v79, v79, v222
    v_mul_f32 v220, v220, v222
    v_mul_f32 v221, v221, v222
    s_nop 3
    s_branch L_at_back11
L_at_rare12:
    s_nop 15
    v_mov_b32 v223, v216
    s_nop 1
    v_permlane32_swap_b32 v216, v223
    v_max_f32 v216, v216, v223
    v_max_f32 v216, 0, v216
    v_sub_f32 v80, v80, v216
    v_sub_f32 v81, v81, v216
    v_sub_f32 v82, v82, v216
    v_sub_f32 v83, v83, v216
    v_sub_f32 v84, v84, v216
    v_sub_f32 v85, v85, v216
    v_sub_f32 v86, v86, v216
    v_sub_f32 v87, v87, v216
    v_sub_f32 v88, v88, v216
    v_sub_f32 v89, v89, v216
    v_sub_f32 v90, v90, v216
    v_sub_f32 v91, v91, v216
    v_sub_f32 v92, v92, v216
    v_sub_f32 v93, v93, v216
    v_sub_f32 v94, v94, v216
    v_sub_f32 v95, v95, v216
    v_sub_f32 v192, v192, v216
    v_sub_f32 v193, v193, v216
    v_sub_f32 v194, v194, v216
    v_sub_f32 v195, v195, v216
    v_sub_f32 v196, v196, v216
    v_sub_f32 v197, v197, v216
    v_sub_f32 v198, v198, v216
    v_sub_f32 v199, v199, v216
    v_sub_f32 v200, v200, v216
    v_sub_f32 v201, v201, v216
    v_sub_f32 v202, v202, v216
    v_sub_f32 v203, v203, v216
    v_sub_f32 v204, v204, v216
    v_sub_f32 v205, v205, v216
    v_sub_f32 v206, v206, v216
    v_sub_f32 v207, v207, v216
    v_sub_f32 v222, 0, v216
    v_exp_f32 v222, v222
    s_nop 0
    v_mul_f32 v16, v16, v222
    v_mul_f32 v17, v17, v222
    v_mul_f32 v18, v18, v222
    v_mul_f32 v19, v19, v222
    v_mul_f32 v20, v20, v222
    v_mul_f32 v21, v21, v222
    v_mul_f32 v22, v22, v222
    v_mul_f32 v23, v23, v222
    v_mul_f32 v24, v24, v222
    v_mul_f32 v25, v25, v222
    v_mul_f32 v26, v26, v222
    v_mul_f32 v27, v27, v222
    v_mul_f32 v28, v28, v222
    v_mul_f32 v29, v29, v222
    v_mul_f32 v30, v30, v222
    v_mul_f32 v31, v31, v222
    v_mul_f32 v32, v32, v222
    v_mul_f32 v33, v33, v222
    v_mul_f32 v34, v34, v222
    v_mul_f32 v35, v35, v222
    v_mul_f32 v36, v36, v222
    v_mul_f32 v37, v37, v222
    v_mul_f32 v38, v38, v222
    v_mul_f32 v39, v39, v222
    v_mul_f32 v40, v40, v222
    v_mul_f32 v41, v41, v222
    v_mul_f32 v42, v42, v222
    v_mul_f32 v43, v43, v222
    v_mul_f32 v44, v44, v222
    v_mul_f32 v45, v45, v222
    v_mul_f32 v46, v46, v222
    v_mul_f32 v47, v47, v222
    v_mul_f32 v48, v48, v222
    v_mul_f32 v49, v49, v222
    v_mul_f32 v50, v50, v222
    v_mul_f32 v51, v51, v222
    v_mul_f32 v52, v52, v222
    v_mul_f32 v53, v53, v222
    v_mul_f32 v54, v54, v222
    v_mul_f32 v55, v55, v222
    v_mul_f32 v56, v56, v222
    v_mul_f32 v57, v57, v222
    v_mul_f32 v58, v58, v222
    v_mul_f32 v59, v59, v222
    v_mul_f32 v60, v60, v222
    v_mul_f32 v61, v61, v222
    v_mul_f32 v62, v62, v222
    v_mul_f32 v63, v63, v222
    v_mul_f32 v64, v64, v222
    v_mul_f32 v65, v65, v222
    v_mul_f32 v66, v66, v222
    v_mul_f32 v67, v67, v222
    v_mul_f32 v68, v68, v222
    v_mul_f32 v69, v69, v222
    v_mul_f32 v70, v70, v222
    v_mul_f32 v71, v71, v222
    v_mul_f32 v72, v72, v222
    v_mul_f32 v73, v73, v222
    v_mul_f32 v74, v74, v222
    v_mul_f32 v75, v75, v222
    v_mul_f32 v76, v76, v222
    v_mul_f32 v77, v77, v222
    v_mul_f32 v78, v78, v222
    v_mul_f32 v79, v79, v222
    v_mul_f32 v220, v220, v222
    v_mul_f32 v221, v221, v222
    s_nop 3
    s_branch L_at_back12
L_at_rare13:
    s_nop 15
    v_mov_b32 v223, v216
    s_nop 1
    v_permlane32_swap_b32 v216, v223
    v_max_f32 v216, v216, v223
    v_max_f32 v216, 0, v216
    v_sub_f32 v96, v96, v216
    v_sub_f32 v97, v97, v216
    v_sub_f32 v98, v98, v216
    v_sub_f32 v99, v99, v216
    v_sub_f32 v100, v100, v216
    v_sub_f32 v101, v101, v216
    v_sub_f32 v102, v102, v216
    v_sub_f32 v103, v103, v216
    v_sub_f32 v104, v104, v216
    v_sub_f32 v105, v105, v216
    v_sub_f32 v106, v106, v216
    v_sub_f32 v107, v107, v216
    v_sub_f32 v108, v108, v216
    v_sub_f32 v109, v109, v216
    v_sub_f32 v110, v110, v216
    v_sub_f32 v111, v111, v216
    v_sub_f32 v192, v192, v216
    v_sub_f32 v193, v193, v216
    v_sub_f32 v194, v194, v216
    v_sub_f32 v195, v195, v216
    v_sub_f32 v196, v196, v216
    v_sub_f32 v197, v197, v216
    v_sub_f32 v198, v198, v216
    v_sub_f32 v199, v199, v216
    v_sub_f32 v200, v200, v216
    v_sub_f32 v201, v201, v216
    v_sub_f32 v202, v202, v216
    v_sub_f32 v203, v203, v216
    v_sub_f32 v204, v204, v216
    v_sub_f32 v205, v205, v216
    v_sub_f32 v206, v206, v216
    v_sub_f32 v207, v207, v216
    v_sub_f32 v222, 0, v216
    v_exp_f32 v222, v222
    s_nop 0
    v_mul_f32 v16, v16, v222
    v_mul_f32 v17, v17, v222
    v_mul_f32 v18, v18, v222
    v_mul_f32 v19, v19, v222
    v_mul_f32 v20, v20, v222
    v_mul_f32 v21, v21, v222
    v_mul_f32 v22, v22, v222
    v_mul_f32 v23, v23, v222
    v_mul_f32 v24, v24, v222
    v_mul_f32 v25, v25, v222
    v_mul_f32 v26, v26, v222
    v_mul_f32 v27, v27, v222
    v_mul_f32 v28, v28, v222
    v_mul_f32 v29, v29, v222
    v_mul_f32 v30, v30, v222
    v_mul_f32 v31, v31, v222
    v_mul_f32 v32, v32, v222
    v_mul_f32 v33, v33, v222
    v_mul_f32 v34, v34, v222
    v_mul_f32 v35, v35, v222
    v_mul_f32 v36, v36, v222
    v_mul_f32 v37, v37, v222
    v_mul_f32 v38, v38, v222
    v_mul_f32 v39, v39, v222
    v_mul_f32 v40, v40, v222
    v_mul_f32 v41, v41, v222
    v_mul_f32 v42, v42, v222
    v_mul_f32 v43, v43, v222
    v_mul_f32 v44, v44, v222
    v_mul_f32 v45, v45, v222
    v_mul_f32 v46, v46, v222
    v_mul_f32 v47, v47, v222
    v_mul_f32 v48, v48, v222
    v_mul_f32 v49, v49, v222
    v_mul_f32 v50, v50, v222
    v_mul_f32 v51, v51, v222
    v_mul_f32 v52, v52, v222
    v_mul_f32 v53, v53, v222
    v_mul_f32 v54, v54, v222
    v_mul_f32 v55, v55, v222
    v_mul_f32 v56, v56, v222
    v_mul_f32 v57, v57, v222
    v_mul_f32 v58, v58, v222
    v_mul_f32 v59, v59, v222
    v_mul_f32 v60, v60, v222
    v_mul_f32 v61, v61, v222
    v_mul_f32 v62, v62, v222
    v_mul_f32 v63, v63, v222
    v_mul_f32 v64, v64, v222
    v_mul_f32 v65, v65, v222
    v_mul_f32 v66, v66, v222
    v_mul_f32 v67, v67, v222
    v_mul_f32 v68, v68, v222
    v_mul_f32 v69, v69, v222
    v_mul_f32 v70, v70, v222
    v_mul_f32 v71, v71, v222
    v_mul_f32 v72, v72, v222
    v_mul_f32 v73, v73, v222
    v_mul_f32 v74, v74, v222
    v_mul_f32 v75, v75, v222
    v_mul_f32 v76, v76, v222
    v_mul_f32 v77, v77, v222
    v_mul_f32 v78, v78, v222
    v_mul_f32 v79, v79, v222
    v_mul_f32 v220, v220, v222
    v_mul_f32 v221, v221, v222
    s_nop 3
    s_branch L_at_back13
L_at_rare14:
    s_nop 15
    v_mov_b32 v223, v216
    s_nop 1
    v_permlane32_swap_b32 v216, v223
    v_max_f32 v216, v216, v223
    v_max_f32 v216, 0, v216
    v_sub_f32 v80, v80, v216
    v_sub_f32 v81, v81, v216
    v_sub_f32 v82, v82, v216
    v_sub_f32 v83, v83, v216
    v_sub_f32 v84, v84, v216
    v_sub_f32 v85, v85, v216
    v_sub_f32 v86, v86, v216
    v_sub_f32 v87, v87, v216
    v_sub_f32 v88, v88, v216
    v_sub_f32 v89, v89, v216
    v_sub_f32 v90, v90, v216
    v_sub_f32 v91, v91, v216
    v_sub_f32 v92, v92, v216
    v_sub_f32 v93, v93, v216
    v_sub_f32 v94, v94, v216
    v_sub_f32 v95, v95, v216
    v_sub_f32 v192, v192, v216
    v_sub_f32 v193, v193, v216
    v_sub_f32 v194, v194, v216
    v_sub_f32 v195, v195, v216
    v_sub_f32 v196, v196, v216
    v_sub_f32 v197, v197, v216
    v_sub_f32 v198, v198, v216
    v_sub_f32 v199, v199, v216
    v_sub_f32 v200, v200, v216
    v_sub_f32 v201, v201, v216
    v_sub_f32 v202, v202, v216
    v_sub_f32 v203, v203, v216
    v_sub_f32 v204, v204, v216
    v_sub_f32 v205, v205, v216
    v_sub_f32 v206, v206, v216
    v_sub_f32 v207, v207, v216
    v_sub_f32 v222, 0, v216
    v_exp_f32 v222, v222
    s_nop 0
    v_mul_f32 v16, v16, v222
    v_mul_f32 v17, v17, v222
    v_mul_f32 v18, v18, v222
    v_mul_f32 v19, v19, v222
    v_mul_f32 v20, v20, v222
    v_mul_f32 v21, v21, v222
    v_mul_f32 v22, v22, v222
    v_mul_f32 v23, v23, v222
    v_mul_f32 v24, v24, v222
    v_mul_f32 v25, v25, v222
    v_mul_f32 v26, v26, v222
    v_mul_f32 v27, v27, v222
    v_mul_f32 v28, v28, v222
    v_mul_f32 v29, v29, v222
    v_mul_f32 v30, v30, v222
    v_mul_f32 v31, v31, v222
    v_mul_f32 v32, v32, v222
    v_mul_f32 v33, v33, v222
    v_mul_f32 v34, v34, v222
    v_mul_f32 v35, v35, v222
    v_mul_f32 v36, v36, v222
    v_mul_f32 v37, v37, v222
    v_mul_f32 v38, v38, v222
    v_mul_f32 v39, v39, v222
    v_mul_f32 v40, v40, v222
    v_mul_f32 v41, v41, v222
    v_mul_f32 v42, v42, v222
    v_mul_f32 v43, v43, v222
    v_mul_f32 v44, v44, v222
    v_mul_f32 v45, v45, v222
    v_mul_f32 v46, v46, v222
    v_mul_f32 v47, v47, v222
    v_mul_f32 v48, v48, v222
    v_mul_f32 v49, v49, v222
    v_mul_f32 v50, v50, v222
    v_mul_f32 v51, v51, v222
    v_mul_f32 v52, v52, v222
    v_mul_f32 v53, v53, v222
    v_mul_f32 v54, v54, v222
    v_mul_f32 v55, v55, v222
    v_mul_f32 v56, v56, v222
    v_mul_f32 v57, v57, v222
    v_mul_f32 v58, v58, v222
    v_mul_f32 v59, v59, v222
    v_mul_f32 v60, v60, v222
    v_mul_f32 v61, v61, v222
    v_mul_f32 v62, v62, v222
    v_mul_f32 v63, v63, v222
    v_mul_f32 v64, v64, v222
    v_mul_f32 v65, v65, v222
    v_mul_f32 v66, v66, v222
    v_mul_f32 v67, v67, v222
    v_mul_f32 v68, v68, v222
    v_mul_f32 v69, v69, v222
    v_mul_f32 v70, v70, v222
    v_mul_f32 v71, v71, v222
    v_mul_f32 v72, v72, v222
    v_mul_f32 v73, v73, v222
    v_mul_f32 v74, v74, v222
    v_mul_f32 v75, v75, v222
    v_mul_f32 v76, v76, v222
    v_mul_f32 v77, v77, v222
    v_mul_f32 v78, v78, v222
    v_mul_f32 v79, v79, v222
    v_mul_f32 v220, v220, v222
    v_mul_f32 v221, v221, v222
    s_nop 3
    s_branch L_at_back14
L_at_rare15:
    s_nop 15
    v_mov_b32 v223, v216
    s_nop 1
    v_permlane32_swap_b32 v216, v223
    v_max_f32 v216, v216, v223
    v_max_f32 v216, 0, v216
    v_sub_f32 v96, v96, v216
    v_sub_f32 v97, v97, v216
    v_sub_f32 v98, v98, v216
    v_sub_f32 v99, v99, v216
    v_sub_f32 v100, v100, v216
    v_sub_f32 v101, v101, v216
    v_sub_f32 v102, v102, v216
    v_sub_f32 v103, v103, v216
    v_sub_f32 v104, v104, v216
    v_sub_f32 v105, v105, v216
    v_sub_f32 v106, v106, v216
    v_sub_f32 v107, v107, v216
    v_sub_f32 v108, v108, v216
    v_sub_f32 v109, v109, v216
    v_sub_f32 v110, v110, v216
    v_sub_f32 v111, v111, v216
    v_sub_f32 v192, v192, v216
    v_sub_f32 v193, v193, v216
    v_sub_f32 v194, v194, v216
    v_sub_f32 v195, v195, v216
    v_sub_f32 v196, v196, v216
    v_sub_f32 v197, v197, v216
    v_sub_f32 v198, v198, v216
    v_sub_f32 v199, v199, v216
    v_sub_f32 v200, v200, v216
    v_sub_f32 v201, v201, v216
    v_sub_f32 v202, v202, v216
    v_sub_f32 v203, v203, v216
    v_sub_f32 v204, v204, v216
    v_sub_f32 v205, v205, v216
    v_sub_f32 v206, v206, v216
    v_sub_f32 v207, v207, v216
    v_sub_f32 v222, 0, v216
    v_exp_f32 v222, v222
    s_nop 0
    v_mul_f32 v16, v16, v222
    v_mul_f32 v17, v17, v222
    v_mul_f32 v18, v18, v222
    v_mul_f32 v19, v19, v222
    v_mul_f32 v20, v20, v222
    v_mul_f32 v21, v21, v222
    v_mul_f32 v22, v22, v222
    v_mul_f32 v23, v23, v222
    v_mul_f32 v24, v24, v222
    v_mul_f32 v25, v25, v222
    v_mul_f32 v26, v26, v222
    v_mul_f32 v27, v27, v222
    v_mul_f32 v28, v28, v222
    v_mul_f32 v29, v29, v222
    v_mul_f32 v30, v30, v222
    v_mul_f32 v31, v31, v222
    v_mul_f32 v32, v32, v222
    v_mul_f32 v33, v33, v222
    v_mul_f32 v34, v34, v222
    v_mul_f32 v35, v35, v222
    v_mul_f32 v36, v36, v222
    v_mul_f32 v37, v37, v222
    v_mul_f32 v38, v38, v222
    v_mul_f32 v39, v39, v222
    v_mul_f32 v40, v40, v222
    v_mul_f32 v41, v41, v222
    v_mul_f32 v42, v42, v222
    v_mul_f32 v43, v43, v222
    v_mul_f32 v44, v44, v222
    v_mul_f32 v45, v45, v222
    v_mul_f32 v46, v46, v222
    v_mul_f32 v47, v47, v222
    v_mul_f32 v48, v48, v222
    v_mul_f32 v49, v49, v222
    v_mul_f32 v50, v50, v222
    v_mul_f32 v51, v51, v222
    v_mul_f32 v52, v52, v222
    v_mul_f32 v53, v53, v222
    v_mul_f32 v54, v54, v222
    v_mul_f32 v55, v55, v222
    v_mul_f32 v56, v56, v222
    v_mul_f32 v57, v57, v222
    v_mul_f32 v58, v58, v222
    v_mul_f32 v59, v59, v222
    v_mul_f32 v60, v60, v222
    v_mul_f32 v61, v61, v222
    v_mul_f32 v62, v62, v222
    v_mul_f32 v63, v63, v222
    v_mul_f32 v64, v64, v222
    v_mul_f32 v65, v65, v222
    v_mul_f32 v66, v66, v222
    v_mul_f32 v67, v67, v222
    v_mul_f32 v68, v68, v222
    v_mul_f32 v69, v69, v222
    v_mul_f32 v70, v70, v222
    v_mul_f32 v71, v71, v222
    v_mul_f32 v72, v72, v222
    v_mul_f32 v73, v73, v222
    v_mul_f32 v74, v74, v222
    v_mul_f32 v75, v75, v222
    v_mul_f32 v76, v76, v222
    v_mul_f32 v77, v77, v222
    v_mul_f32 v78, v78, v222
    v_mul_f32 v79, v79, v222
    v_mul_f32 v220, v220, v222
    v_mul_f32 v221, v221, v222
    s_nop 3
    s_branch L_at_back15
L_at_end:
    s_endpgm
.globl gemm2_kernel
.p2align 8
.type gemm2_kernel,@function
gemm2_kernel:
    s_cmp_ge_u32 s2, 256
    s_cbranch_scc1 L_g2_end
    s_load_dwordx2 s[4:5], s[0:1], 32
    s_load_dwordx2 s[6:7], s[0:1], 64
    s_load_dwordx2 s[8:9], s[0:1], 88
    v_lshrrev_b32 v1, 6, v0
    v_and_b32 v2, 63, v0
    v_readfirstlane_b32 s40, v1
    s_nop 3
    s_lshr_b32 s39, s40, 2
    s_and_b32 s40, s40, 3
    s_and_b32 s41, s2, 3
    s_lshr_b32 s42, s2, 2
    s_and_b32 s42, s42, 1
    s_lshr_b32 s43, s2, 5
    s_lshl_b32 s42, s42, 3
    s_add_u32 s42, s42, s43
    s_lshr_b32 s43, s2, 3
    s_and_b32 s43, s43, 3
    s_mov_b32 s44, 0
    s_mov_b32 s45, 22
    s_cmp_eq_u32 s41, 1
    s_cselect_b32 s44, 1408, s44
    s_cselect_b32 s45, 21, s45
    s_cmp_eq_u32 s41, 2
    s_cselect_b32 s44, 2752, s44
    s_cselect_b32 s45, 21, s45
    s_mov_b32 s46, 262144
    s_mov_b32 s47, 2097152
    s_cmp_eq_u32 s41, 3
    s_cselect_b32 s46, 90112, s46
    s_cselect_b32 s47, 18874368, s47
    s_mul_i32 s48, s42, s46
    s_lshl_b32 s48, s48, 2
    s_add_u32 s47, s47, s48
    s_lshl_b32 s48, s44, 6
    s_add_u32 s47, s47, s48
    s_lshl_b32 s49, s44, 10
    s_lshl_b32 s48, s43, 8
    s_add_u32 s49, s49, s48
    s_waitcnt lgkmcnt(0)
    s_mov_b32 s50, 4194304
    s_cmp_eq_u32 s41, 3
    s_cselect_b32 s4, s6, s4
    s_cselect_b32 s5, s7, s5
    s_cselect_b32 s50, 1409024, s50
    s_sub_u32 s50, s50, s49
    s_add_u32 s12, s8, s47
    s_addc_u32 s13, s9, 0
    s_and_b32 s13, s13, 65535
    s_lshl_b32 s51, s46, 2
    s_mov_b32 s14, s51
    s_mov_b32 s15, 131072
    s_add_u32 s16, s4, s49
    s_addc_u32 s17, s5, 0
    s_and_b32 s17, s17, 65535
    s_mov_b32 s18, s50
    s_mov_b32 s19, 131072
    s_add_u32 s20, s8, 25165824
    s_addc_u32 s21, s9, 0
    s_and_b32 s21, s21, 65535
    s_mov_b32 s22, 16777216
    s_mov_b32 s23, 131072
    v_lshlrev_b32 v3, 4, v2
    v_lshrrev_b32 v4, 4, v2
    v_bfe_u32 v5, v2, 2, 2
    v_xor_b32 v5, v5, v4
    v_lshlrev_b32 v5, 6, v5
    v_lshl_add_u32 v5, v4, 10, v5
    v_and_b32 v4, 3, v2
    v_lshl_add_u32 v6, v4, 4, v5
    s_add_u32 s53, s40, 0
    s_mul_i32 s56, s40, s46
    s_add_u32 s56, s56, 0
    s_lshl_b32 s60, s53, 12
    s_add_u32 s53, s40, 4
    s_mul_i32 s57, s40, s46
    s_add_u32 s57, s57, 1024
    s_lshl_b32 s61, s53, 12
    s_add_u32 s53, s40, 8
    s_mul_i32 s58, s40, s46
    s_add_u32 s58, s58, 2048
    s_lshl_b32 s62, s53, 12
    s_add_u32 s53, s40, 12
    s_mul_i32 s59, s40, s46
    s_add_u32 s59, s59, 3072
    s_lshl_b32 s63, s53, 12
    s_lshl_b32 s64, s40, 10
    s_lshl_b32 s82, s40, 12
    s_mov_b32 s65, 0
    s_mov_b32 s66, 0
    s_lshr_b32 s84, s2, 3
    s_mul_i32 s84, s84, 1
    s_cmp_ge_u32 s84, s45
    s_cselect_b32 s85, s45, 0
    s_sub_u32 s84, s84, s85
    s_cmp_ge_u32 s84, s45
    s_cselect_b32 s85, s45, 0
    s_sub_u32 s84, s84, s85
    s_cmp_ge_u32 s84, s45
    s_cselect_b32 s85, s45, 0
    s_sub_u32 s84, s84, s85
    s_cmp_ge_u32 s84, s45
    s_cselect_b32 s85, s45, 0
    s_sub_u32 s84, s84, s85
    s_cmp_ge_u32 s84, s45
    s_cselect_b32 s85, s45, 0
    s_sub_u32 s84, s84, s85
    s_cmp_ge_u32 s84, s45
    s_cselect_b32 s85, s45, 0
    s_sub_u32 s84, s84, s85
    s_cmp_ge_u32 s84, s45
    s_cselect_b32 s85, s45, 0
    s_sub_u32 s84, s84, s85
    s_cmp_ge_u32 s84, s45
    s_cselect_b32 s85, s45, 0
    s_sub_u32 s84, s84, s85
    s_cmp_ge_u32 s84, s45
    s_cselect_b32 s85, s45, 0
    s_sub_u32 s84, s84, s85
    s_cmp_ge_u32 s84, s45
    s_cselect_b32 s85, s45, 0
    s_sub_u32 s84, s84, s85
    s_cmp_ge_u32 s84, s45
    s_cselect_b32 s85, s45, 0
    s_sub_u32 s84, s84, s85
    s_cmp_ge_u32 s84, s45
    s_cselect_b32 s85, s45, 0
    s_sub_u32 s84, s84, s85
    s_cmp_eq_u32 s39, 0
    s_cbranch_scc1 L_g2_compute
    s_cmp_lt_u32 s65, s45
    s_cselect_b32 s14, s51, 0
    s_cselect_b32 s18, s50, 0
    s_add_u32 s67, s66, s64
    s_add_u32 s83, s66, s82
    s_lshl_b32 s85, s84, 12
    s_lshl_b32 s86, s84, 16
    s_add_u32 m0, s83, 0
    s_add_u32 s87, s56, s85
    buffer_load_dwordx4 v3, s[12:15], s87 offen lds
    s_add_u32 m0, s83, 1024
    s_add_u32 s87, s57, s85
    buffer_load_dwordx4 v3, s[12:15], s87 offen lds
    s_add_u32 m0, s83, 2048
    s_add_u32 s87, s58, s85
    buffer_load_dwordx4 v3, s[12:15], s87 offen lds
    s_add_u32 m0, s83, 3072
    s_add_u32 s87, s59, s85
    buffer_load_dwordx4 v3, s[12:15], s87 offen lds
    s_add_u32 m0, s67, 16384
    s_add_u32 s87, s60, s86
    buffer_load_dwordx4 v6, s[16:19], s87 offen lds
    s_add_u32 m0, s67, 20480
    s_add_u32 s87, s61, s86
    buffer_load_dwordx4 v6, s[16:19], s87 offen lds
    s_add_u32 m0, s67, 24576
    s_add_u32 s87, s62, s86
    buffer_load_dwordx4 v6, s[16:19], s87 offen lds
    s_add_u32 m0, s67, 28672
    s_add_u32 s87, s63, s86
    buffer_load_dwordx4 v6, s[16:19], s87 offen lds
    s_add_u32 s65, s65, 1
    s_add_u32 s84, s84, 1
    s_cmp_eq_u32 s84, s45
    s_cselect_b32 s84, 0, s84
    s_add_u32 s66, s66, 32768
    s_cmp_eq_u32 s66, 163840
    s_cselect_b32 s66, 0, s66
    s_cmp_lt_u32 s65, s45
    s_cselect_b32 s14, s51, 0
    s_cselect_b32 s18, s50, 0
    s_add_u32 s67, s66, s64
    s_add_u32 s83, s66, s82
    s_lshl_b32 s85, s84, 12
    s_lshl_b32 s86, s84, 16
    s_add_u32 m0, s83, 0
    s_add_u32 s87, s56, s85
    buffer_load_dwordx4 v3, s[12:15], s87 offen lds
    s_add_u32 m0, s83, 1024
    s_add_u32 s87, s57, s85
    buffer_load_dwordx4 v3, s[12:15], s87 offen lds
    s_add_u32 m0, s83, 2048
    s_add_u32 s87, s58, s85
    buffer_load_dwordx4 v3, s[12:15], s87 offen lds
    s_add_u32 m0, s83, 3072
    s_add_u32 s87, s59, s85
    buffer_load_dwordx4 v3, s[12:15], s87 offen lds
    s_add_u32 m0, s67, 16384
    s_add_u32 s87, s60, s86
    buffer_load_dwordx4 v6, s[16:19], s87 offen lds
    s_add_u32 m0, s67, 20480
    s_add_u32 s87, s61, s86
    buffer_load_dwordx4 v6, s[16:19], s87 offen lds
    s_add_u32 m0, s67, 24576
    s_add_u32 s87, s62, s86
    buffer_load_dwordx4 v6, s[16:19], s87 offen lds
    s_add_u32 m0, s67, 28672
    s_add_u32 s87, s63, s86
    buffer_load_dwordx4 v6, s[16:19], s87 offen lds
    s_add_u32 s65, s65, 1
    s_add_u32 s84, s84, 1
    s_cmp_eq_u32 s84, s45
    s_cselect_b32 s84, 0, s84
    s_add_u32 s66, s66, 32768
    s_cmp_eq_u32 s66, 163840
    s_cselect_b32 s66, 0, s66
    s_cmp_lt_u32 s65, s45
    s_cselect_b32 s14, s51, 0
    s_cselect_b32 s18, s50, 0
    s_add_u32 s67, s66, s64
    s_add_u32 s83, s66, s82
    s_lshl_b32 s85, s84, 12
    s_lshl_b32 s86, s84, 16
    s_add_u32 m0, s83, 0
    s_add_u32 s87, s56, s85
    buffer_load_dwordx4 v3, s[12:15], s87 offen lds
    s_add_u32 m0, s83, 1024
    s_add_u32 s87, s57, s85
    buffer_load_dwordx4 v3, s[12:15], s87 offen lds
    s_add_u32 m0, s83, 2048
    s_add_u32 s87, s58, s85
    buffer_load_dwordx4 v3, s[12:15], s87 offen lds
    s_add_u32 m0, s83, 3072
    s_add_u32 s87, s59, s85
    buffer_load_dwordx4 v3, s[12:15], s87 offen lds
    s_add_u32 m0, s67, 16384
    s_add_u32 s87, s60, s86
    buffer_load_dwordx4 v6, s[16:19], s87 offen lds
    s_add_u32 m0, s67, 20480
    s_add_u32 s87, s61, s86
    buffer_load_dwordx4 v6, s[16:19], s87 offen lds
    s_add_u32 m0, s67, 24576
    s_add_u32 s87, s62, s86
    buffer_load_dwordx4 v6, s[16:19], s87 offen lds
    s_add_u32 m0, s67, 28672
    s_add_u32 s87, s63, s86
    buffer_load_dwordx4 v6, s[16:19], s87 offen lds
    s_add_u32 s65, s65, 1
    s_add_u32 s84, s84, 1
    s_cmp_eq_u32 s84, s45
    s_cselect_b32 s84, 0, s84
    s_add_u32 s66, s66, 32768
    s_cmp_eq_u32 s66, 163840
    s_cselect_b32 s66, 0, s66
    s_cmp_lt_u32 s65, s45
    s_cselect_b32 s14, s51, 0
    s_cselect_b32 s18, s50, 0
    s_add_u32 s67, s66, s64
    s_add_u32 s83, s66, s82
    s_lshl_b32 s85, s84, 12
    s_lshl_b32 s86, s84, 16
    s_add_u32 m0, s83, 0
    s_add_u32 s87, s56, s85
    buffer_load_dwordx4 v3, s[12:15], s87 offen lds
    s_add_u32 m0, s83, 1024
    s_add_u32 s87, s57, s85
    buffer_load_dwordx4 v3, s[12:15], s87 offen lds
    s_add_u32 m0, s83, 2048
    s_add_u32 s87, s58, s85
    buffer_load_dwordx4 v3, s[12:15], s87 offen lds
    s_add_u32 m0, s83, 3072
    s_add_u32 s87, s59, s85
    buffer_load_dwordx4 v3, s[12:15], s87 offen lds
    s_add_u32 m0, s67, 16384
    s_add_u32 s87, s60, s86
    buffer_load_dwordx4 v6, s[16:19], s87 offen lds
    s_add_u32 m0, s67, 20480
    s_add_u32 s87, s61, s86
    buffer_load_dwordx4 v6, s[16:19], s87 offen lds
    s_add_u32 m0, s67, 24576
    s_add_u32 s87, s62, s86
    buffer_load_dwordx4 v6, s[16:19], s87 offen lds
    s_add_u32 m0, s67, 28672
    s_add_u32 s87, s63, s86
    buffer_load_dwordx4 v6, s[16:19], s87 offen lds
    s_add_u32 s65, s65, 1
    s_add_u32 s84, s84, 1
    s_cmp_eq_u32 s84, s45
    s_cselect_b32 s84, 0, s84
    s_add_u32 s66, s66, 32768
    s_cmp_eq_u32 s66, 163840
    s_cselect_b32 s66, 0, s66
    s_waitcnt vmcnt(24)
    s_barrier
    s_mov_b32 s78, 0
L_g2_lloop:
    s_waitcnt vmcnt(16)
    s_barrier
    s_cmp_lt_u32 s65, s45
    s_cselect_b32 s14, s51, 0
    s_cselect_b32 s18, s50, 0
    s_add_u32 s67, s66, s64
    s_add_u32 s83, s66, s82
    s_lshl_b32 s85, s84, 12
    s_lshl_b32 s86, s84, 16
    s_add_u32 m0, s83, 0
    s_add_u32 s87, s56, s85
    buffer_load_dwordx4 v3, s[12:15], s87 offen lds
    s_add_u32 m0, s83, 1024
    s_add_u32 s87, s57, s85
    buffer_load_dwordx4 v3, s[12:15], s87 offen lds
    s_add_u32 m0, s83, 2048
    s_add_u32 s87, s58, s85
    buffer_load_dwordx4 v3, s[12:15], s87 offen lds
    s_add_u32 m0, s83, 3072
    s_add_u32 s87, s59, s85
    buffer_load_dwordx4 v3, s[12:15], s87 offen lds
    s_add_u32 m0, s67, 16384
    s_add_u32 s87, s60, s86
    buffer_load_dwordx4 v6, s[16:19], s87 offen lds
    s_add_u32 m0, s67, 20480
    s_add_u32 s87, s61, s86
    buffer_load_dwordx4 v6, s[16:19], s87 offen lds
    s_add_u32 m0, s67, 24576
    s_add_u32 s87, s62, s86
    buffer_load_dwordx4 v6, s[16:19], s87 offen lds
    s_add_u32 m0, s67, 28672
    s_add_u32 s87, s63, s86
    buffer_load_dwordx4 v6, s[16:19], s87 offen lds
    s_add_u32 s65, s65, 1
    s_add_u32 s84, s84, 1
    s_cmp_eq_u32 s84, s45
    s_cselect_b32 s84, 0, s84
    s_add_u32 s66, s66, 32768
    s_cmp_eq_u32 s66, 163840
    s_cselect_b32 s66, 0, s66
    s_add_u32 s78, s78, 1
    s_cmp_lt_u32 s78, s45
    s_cbranch_scc1 L_g2_lloop
    s_waitcnt vmcnt(0)
    s_endpgm
L_g2_compute:
    s_lshr_b32 s68, s40, 1
    s_and_b32 s69, s40, 1
    v_lshrrev_b32 v7, 5, v2
    s_lshl_b32 s53, s68, 13
    v_lshl_add_u32 v8, v2, 4, s53
    v_bfe_u32 v4, v2, 2, 2
    v_lshl_add_u32 v5, v7, 3, v4
    v_lshlrev_b32 v5, 8, v5
    v_add_u32 v5, 16384, v5
    v_bfe_u32 v14, v2, 4, 1
    v_lshl_add_u32 v5, v14, 5, v5
    v_and_b32 v15, 1, v2
    v_lshlrev_b32 v14, 4, v15
    v_and_b32 v15, 2, v2
    v_lshl_add_u32 v14, v15, 2, v14
    v_add_u32 v5, v5, v14
    s_lshl_b32 s53, s69, 1
    s_add_u32 s54, s53, 0
    v_xor_b32 v14, s54, v4
    v_lshl_add_u32 v12, v14, 6, v5
    s_add_u32 s54, s53, 1
    v_xor_b32 v14, s54, v4
    v_lshl_add_u32 v13, v14, 6, v5
    v_mov_b32 v80, 0
    v_mov_b32 v81, 0
    v_mov_b32 v82, 0
    v_mov_b32 v83, 0
    v_mov_b32 v84, 0
    v_mov_b32 v85, 0
    v_mov_b32 v86, 0
    v_mov_b32 v87, 0
    v_mov_b32 v88, 0
    v_mov_b32 v89, 0
    v_mov_b32 v90, 0
    v_mov_b32 v91, 0
    v_mov_b32 v92, 0
    v_mov_b32 v93, 0
    v_mov_b32 v94, 0
    v_mov_b32 v95, 0
    v_mov_b32 v96, 0
    v_mov_b32 v97, 0
    v_mov_b32 v98, 0
    v_mov_b32 v99, 0
    v_mov_b32 v100, 0
    v_mov_b32 v101, 0
    v_mov_b32 v102, 0
    v_mov_b32 v103, 0
    v_mov_b32 v104, 0
    v_mov_b32 v105, 0
    v_mov_b32 v106, 0
    v_mov_b32 v107, 0
    v_mov_b32 v108, 0
    v_mov_b32 v109, 0
    v_mov_b32 v110, 0
    v_mov_b32 v111, 0
    v_mov_b32 v112, 0
    v_mov_b32 v113, 0
    v_mov_b32 v114, 0
    v_mov_b32 v115, 0
    v_mov_b32 v116, 0
    v_mov_b32 v117, 0
    v_mov_b32 v118, 0
    v_mov_b32 v119, 0
    v_mov_b32 v120, 0
    v_mov_b32 v121, 0
    v_mov_b32 v122, 0
    v_mov_b32 v123, 0
    v_mov_b32 v124, 0
    v_mov_b32 v125, 0
    v_mov_b32 v126, 0
    v_mov_b32 v127, 0
    v_mov_b32 v128, 0
    v_mov_b32 v129, 0
    v_mov_b32 v130, 0
    v_mov_b32 v131, 0
    v_mov_b32 v132, 0
    v_mov_b32 v133, 0
    v_mov_b32 v134, 0
    v_mov_b32 v135, 0
    v_mov_b32 v136, 0
    v_mov_b32 v137, 0
    v_mov_b32 v138, 0
    v_mov_b32 v139, 0
    v_mov_b32 v140, 0
    v_mov_b32 v141, 0
    v_mov_b32 v142, 0
    v_mov_b32 v143, 0
    s_barrier
    ds_read_b64_tr_b16 v[16:17], v12 offset:0
    ds_read_b64_tr_b16 v[18:19], v12 offset:1024
    ds_read_b64_tr_b16 v[20:21], v13 offset:0
    ds_read_b64_tr_b16 v[22:23], v13 offset:1024
    ds_read_b128 v[24:27], v8 offset:0
    ds_read_b128 v[28:31], v8 offset:4096
    ds_read_b64_tr_b16 v[32:33], v12 offset:4096
    ds_read_b64_tr_b16 v[34:35], v12 offset:5120
    ds_read_b64_tr_b16 v[36:37], v13 offset:4096
    ds_read_b64_tr_b16 v[38:39], v13 offset:5120
    ds_read_b128 v[40:43], v8 offset:1024
    ds_read_b128 v[44:47], v8 offset:5120
    s_mov_b32 s78, 0
    s_mov_b32 s79, 0
    s_mov_b32 s81, 32768
L_g2_loop:
    s_waitcnt lgkmcnt(6)
    v_mfma_f32_32x32x16_bf16 v[80:95], v[16:19], v[24:27], v[80:95]
    ds_read_b64_tr_b16 v[48:49], v12 offset:8192
    ds_read_b64_tr_b16 v[50:51], v12 offset:9216
    v_mfma_f32_32x32x16_bf16 v[96:111], v[16:19], v[28:31], v[96:111]
    ds_read_b64_tr_b16 v[52:53], v13 offset:8192
    ds_read_b64_tr_b16 v[54:55], v13 offset:9216
    v_mfma_f32_32x32x16_bf16 v[112:127], v[20:23], v[24:27], v[112:127]
    ds_read_b128 v[56:59], v8 offset:2048
    v_mfma_f32_32x32x16_bf16 v[128:143], v[20:23], v[28:31], v[128:143]
    ds_read_b128 v[60:63], v8 offset:6144
    s_waitcnt lgkmcnt(6)
    v_mfma_f32_32x32x16_bf16 v[80:95], v[32:35], v[40:43], v[80:95]
    ds_read_b64_tr_b16 v[64:65], v12 offset:12288
    ds_read_b64_tr_b16 v[66:67], v12 offset:13312
    v_mfma_f32_32x32x16_bf16 v[96:111], v[32:35], v[44:47], v[96:111]
    ds_read_b64_tr_b16 v[68:69], v13 offset:12288
    ds_read_b64_tr_b16 v[70:71], v13 offset:13312
    v_mfma_f32_32x32x16_bf16 v[112:127], v[36:39], v[40:43], v[112:127]
    ds_read_b128 v[72:75], v8 offset:3072
    v_mfma_f32_32x32x16_bf16 v[128:143], v[36:39], v[44:47], v[128:143]
    ds_read_b128 v[76:79], v8 offset:7168
    s_barrier
    s_add_u32 s79, s79, 32768
    s_cmp_eq_u32 s79, 163840
    s_cselect_b32 s79, 0, s79
    s_cselect_b32 s80, 4294836224, s81
    v_add_u32 v8, s80, v8
    v_add_u32 v12, s80, v12
    v_add_u32 v13, s80, v13
    s_waitcnt lgkmcnt(6)
    v_mfma_f32_32x32x16_bf16 v[80:95], v[48:51], v[56:59], v[80:95]
    ds_read_b64_tr_b16 v[16:17], v12 offset:0
    ds_read_b64_tr_b16 v[18:19], v12 offset:1024
    v_mfma_f32_32x32x16_bf16 v[96:111], v[48:51], v[60:63], v[96:111]
    ds_read_b64_tr_b16 v[20:21], v13 offset:0
    ds_read_b64_tr_b16 v[22:23], v13 offset:1024
    v_mfma_f32_32x32x16_bf16 v[112:127], v[52:55], v[56:59], v[112:127]
    ds_read_b128 v[24:27], v8 offset:0
    v_mfma_f32_32x32x16_bf16 v[128:143], v[52:55], v[60:63], v[128:143]
    ds_read_b128 v[28:31], v8 offset:4096
    s_waitcnt lgkmcnt(6)
    v_mfma_f32_32x32x16_bf16 v[80:95], v[64:67], v[72:75], v[80:95]
    ds_read_b64_tr_b16 v[32:33], v12 offset:4096
    ds_read_b64_tr_b16 v[34:35], v12 offset:5120
    v_mfma_f32_32x32x16_bf16 v[96:111], v[64:67], v[76:79], v[96:111]
    ds_read_b64_tr_b16 v[36:37], v13 offset:4096
    ds_read_b64_tr_b16 v[38:39], v13 offset:5120
    v_mfma_f32_32x32x16_bf16 v[112:127], v[68:71], v[72:75], v[112:127]
    ds_read_b128 v[40:43], v8 offset:1024
    v_mfma_f32_32x32x16_bf16 v[128:143], v[68:71], v[76:79], v[128:143]
    ds_read_b128 v[44:47], v8 offset:5120
    s_add_u32 s78, s78, 1
    s_cmp_lt_u32 s78, s45
    s_cbranch_scc1 L_g2_loop
    s_nop 15
    s_lshl_b32 s53, s41, 6
    s_lshl_b32 s54, s42, 2
    s_add_u32 s53, s53, s54
    s_add_u32 s53, s53, s43
    s_lshl_b32 s53, s53, 2
    s_add_u32 s53, s53, s40
    s_lshl_b32 s53, s53, 14
    v_lshlrev_b32 v4, 4, v2
    s_lshr_b32 s53, s53, 1
    v_cvt_pk_bf16_f32 v16, v80, v81
    v_cvt_pk_bf16_f32 v17, v82, v83
    v_cvt_pk_bf16_f32 v18, v84, v85
    v_cvt_pk_bf16_f32 v19, v86, v87
    buffer_store_dwordx4 v[16:19], v4, s[20:23], s53 offen offset:0 sc1
    v_cvt_pk_bf16_f32 v20, v88, v89
    v_cvt_pk_bf16_f32 v21, v90, v91
    v_cvt_pk_bf16_f32 v22, v92, v93
    v_cvt_pk_bf16_f32 v23, v94, v95
    buffer_store_dwordx4 v[20:23], v4, s[20:23], s53 offen offset:1024 sc1
    v_cvt_pk_bf16_f32 v24, v96, v97
    v_cvt_pk_bf16_f32 v25, v98, v99
    v_cvt_pk_bf16_f32 v26, v100, v101
    v_cvt_pk_bf16_f32 v27, v102, v103
    buffer_store_dwordx4 v[24:27], v4, s[20:23], s53 offen offset:2048 sc1
    v_cvt_pk_bf16_f32 v28, v104, v105
    v_cvt_pk_bf16_f32 v29, v106, v107
    v_cvt_pk_bf16_f32 v30, v108, v109
    v_cvt_pk_bf16_f32 v31, v110, v111
    buffer_store_dwordx4 v[28:31], v4, s[20:23], s53 offen offset:3072 sc1
    v_cvt_pk_bf16_f32 v32, v112, v113
    v_cvt_pk_bf16_f32 v33, v114, v115
    v_cvt_pk_bf16_f32 v34, v116, v117
    v_cvt_pk_bf16_f32 v35, v118, v119
    s_add_u32 s53, s53, 4096
    buffer_store_dwordx4 v[32:35], v4, s[20:23], s53 offen offset:0 sc1
    v_cvt_pk_bf16_f32 v36, v120, v121
    v_cvt_pk_bf16_f32 v37, v122, v123
    v_cvt_pk_bf16_f32 v38, v124, v125
    v_cvt_pk_bf16_f32 v39, v126, v127
    buffer_store_dwordx4 v[36:39], v4, s[20:23], s53 offen offset:1024 sc1
    v_cvt_pk_bf16_f32 v40, v128, v129
    v_cvt_pk_bf16_f32 v41, v130, v131
    v_cvt_pk_bf16_f32 v42, v132, v133
    v_cvt_pk_bf16_f32 v43, v134, v135
    buffer_store_dwordx4 v[40:43], v4, s[20:23], s53 offen offset:2048 sc1
    v_cvt_pk_bf16_f32 v44, v136, v137
    v_cvt_pk_bf16_f32 v45, v138, v139
    v_cvt_pk_bf16_f32 v46, v140, v141
    v_cvt_pk_bf16_f32 v47, v142, v143
    buffer_store_dwordx4 v[44:47], v4, s[20:23], s53 offen offset:3072 sc1
    s_waitcnt vmcnt(0)
L_g2_end:
    s_endpgm
.globl fin_kernel
.p2align 8
.type fin_kernel,@function
fin_kernel:
    s_cmp_ge_u32 s2, 512
    s_cbranch_scc1 L_fin_end
    s_load_dwordx2 s[4:5], s[0:1], 0
    s_load_dwordx2 s[6:7], s[0:1], 72
    s_load_dwordx2 s[16:17], s[0:1], 88
    v_and_b32 v1, 63, v0
    v_lshrrev_b32 v2, 6, v0
    v_and_b32 v3, 1, v2
    v_lshrrev_b32 v4, 1, v2
    s_and_b32 s20, s2, 1
    s_lshr_b32 s21, s2, 1
    s_and_b32 s21, s21, 3
    s_lshr_b32 s22, s2, 3
    s_lshr_b32 s23, s2, 1
    s_lshl_b32 s23, s23, 13
    s_lshl_b32 s24, s20, 12
    s_add_u32 s23, s23, s24
    v_lshlrev_b32 v5, 11, v4
    v_lshl_add_u32 v5, v3, 10, v5
    v_lshl_add_u32 v5, v1, 4, v5
    s_lshr_b32 s25, s22, 2
    s_and_b32 s26, s22, 3
    s_lshr_b32 s27, s21, 1
    s_and_b32 s28, s21, 1
    s_lshl_b32 s25, s25, 7
    s_lshl_b32 s27, s27, 6
    s_add_u32 s25, s25, s27
    s_lshl_b32 s25, s25, 10
    s_lshl_b32 s26, s26, 7
    s_lshl_b32 s28, s28, 6
    s_add_u32 s26, s26, s28
    s_lshl_b32 s29, s20, 5
    s_add_u32 s26, s26, s29
    s_lshl_b32 s26, s26, 1
    s_add_u32 s25, s25, s26
    v_and_b32 v6, 31, v1
    v_lshl_add_u32 v6, v4, 5, v6
    v_lshlrev_b32 v6, 10, v6
    v_lshl_add_u32 v6, v3, 5, v6
    v_lshrrev_b32 v7, 5, v1
    v_lshl_add_u32 v6, v7, 4, v6
    s_waitcnt lgkmcnt(0)
    s_mov_b32 s8, s4
    s_and_b32 s9, s5, 65535
    s_mov_b32 s10, 2097152
    s_mov_b32 s11, 131072
    s_mov_b32 s12, s6
    s_and_b32 s13, s7, 65535
    s_mov_b32 s14, 2097152
    s_mov_b32 s15, 131072
    s_add_u32 s32, s16, 25165824
    s_addc_u32 s33, s17, 0
    s_and_b32 s33, s33, 65535
    s_mov_b32 s34, 16777216
    s_mov_b32 s35, 131072
    s_add_u32 s36, s23, 0
    s_add_u32 s37, s23, 2097152
    s_add_u32 s38, s23, 4194304
    s_add_u32 s39, s23, 6291456
    buffer_load_dwordx4 v[52:55], v5, s[32:35], s36 offen
    buffer_load_dwordx4 v[56:59], v5, s[32:35], s37 offen
    buffer_load_dwordx4 v[60:63], v5, s[32:35], s38 offen
    buffer_load_dwordx4 v[64:67], v5, s[32:35], s39 offen
    buffer_load_dwordx4 v[40:43], v6, s[8:11], s25 offen
    s_waitcnt vmcnt(2)
    v_lshlrev_b32 v8, 16, v52
    v_and_b32 v9, 4294901760, v52
    v_lshlrev_b32 v10, 16, v53
    v_and_b32 v11, 4294901760, v53
    v_lshlrev_b32 v12, 16, v54
    v_and_b32 v13, 4294901760, v54
    v_lshlrev_b32 v14, 16, v55
    v_and_b32 v15, 4294901760, v55
    v_lshlrev_b32 v16, 16, v56
    v_and_b32 v17, 4294901760, v56
    v_lshlrev_b32 v18, 16, v57
    v_and_b32 v19, 4294901760, v57
    v_lshlrev_b32 v20, 16, v58
    v_and_b32 v21, 4294901760, v58
    v_lshlrev_b32 v22, 16, v59
    v_and_b32 v23, 4294901760, v59
    v_lshlrev_b32 v24, 16, v60
    v_and_b32 v25, 4294901760, v60
    v_lshlrev_b32 v26, 16, v61
    v_and_b32 v27, 4294901760, v61
    v_lshlrev_b32 v28, 16, v62
    v_and_b32 v29, 4294901760, v62
    v_lshlrev_b32 v30, 16, v63
    v_and_b32 v31, 4294901760, v63
    v_add_f32 v8, v8, v16
    v_add_f32 v8, v8, v24
    v_add_f32 v9, v9, v17
    v_add_f32 v9, v9, v25
    v_add_f32 v10, v10, v18
    v_add_f32 v10, v10, v26
    v_add_f32 v11, v11, v19
    v_add_f32 v11, v11, v27
    v_add_f32 v12, v12, v20
    v_add_f32 v12, v12, v28
    v_add_f32 v13, v13, v21
    v_add_f32 v13, v13, v29
    v_add_f32 v14, v14, v22
    v_add_f32 v14, v14, v30
    v_add_f32 v15, v15, v23
    v_add_f32 v15, v15, v31
    s_waitcnt vmcnt(1)
    v_cvt_pk_bf16_f32 v44, v8, v9
    v_cvt_pk_bf16_f32 v45, v10, v11
    v_cvt_pk_bf16_f32 v46, v12, v13
    v_cvt_pk_bf16_f32 v47, v14, v15
    v_lshlrev_b32 v8, 16, v44
    v_and_b32 v9, 4294901760, v44
    v_lshlrev_b32 v32, 16, v64
    v_and_b32 v33, 4294901760, v64
    v_lshlrev_b32 v10, 16, v45
    v_and_b32 v11, 4294901760, v45
    v_lshlrev_b32 v34, 16, v65
    v_and_b32 v35, 4294901760, v65
    v_lshlrev_b32 v12, 16, v46
    v_and_b32 v13, 4294901760, v46
    v_lshlrev_b32 v36, 16, v66
    v_and_b32 v37, 4294901760, v66
    v_lshlrev_b32 v14, 16, v47
    v_and_b32 v15, 4294901760, v47
    v_lshlrev_b32 v38, 16, v67
    v_and_b32 v39, 4294901760, v67
    v_mul_f32 v16, 0xbfb8aa3b, v32
    v_mul_f32 v17, 0xbfb8aa3b, v33
    v_mul_f32 v18, 0xbfb8aa3b, v34
    v_mul_f32 v19, 0xbfb8aa3b, v35
    v_mul_f32 v20, 0xbfb8aa3b, v36
    v_mul_f32 v21, 0xbfb8aa3b, v37
    v_mul_f32 v22, 0xbfb8aa3b, v38
    v_mul_f32 v23, 0xbfb8aa3b, v39
    v_exp_f32 v16, v16
    v_exp_f32 v17, v17
    v_exp_f32 v18, v18
    v_exp_f32 v19, v19
    v_exp_f32 v20, v20
    v_exp_f32 v21, v21
    v_exp_f32 v22, v22
    v_exp_f32 v23, v23
    v_add_f32 v16, 1.0, v16
    v_add_f32 v17, 1.0, v17
    v_add_f32 v18, 1.0, v18
    v_add_f32 v19, 1.0, v19
    v_add_f32 v20, 1.0, v20
    v_add_f32 v21, 1.0, v21
    v_add_f32 v22, 1.0, v22
    v_add_f32 v23, 1.0, v23
    v_rcp_f32 v16, v16
    v_rcp_f32 v17, v17
    v_rcp_f32 v18, v18
    v_rcp_f32 v19, v19
    v_rcp_f32 v20, v20
    v_rcp_f32 v21, v21
    v_rcp_f32 v22, v22
    v_rcp_f32 v23, v23
    v_mul_f32 v16, v16, v32
    v_mul_f32 v17, v17, v33
    v_mul_f32 v18, v18, v34
    v_mul_f32 v19, v19, v35
    v_mul_f32 v20, v20, v36
    v_mul_f32 v21, v21, v37
    v_mul_f32 v22, v22, v38
    v_mul_f32 v23, v23, v39
    v_cvt_pk_bf16_f32 v48, v16, v17
    v_cvt_pk_bf16_f32 v49, v18, v19
    v_cvt_pk_bf16_f32 v50, v20, v21
    v_cvt_pk_bf16_f32 v51, v22, v23
    v_lshlrev_b32 v16, 16, v48
    v_and_b32 v17, 4294901760, v48
    v_lshlrev_b32 v18, 16, v49
    v_and_b32 v19, 4294901760, v49
    v_lshlrev_b32 v20, 16, v50
    v_and_b32 v21, 4294901760, v50
    v_lshlrev_b32 v22, 16, v51
    v_and_b32 v23, 4294901760, v51
    v_mul_f32 v8, v8, v16
    v_mul_f32 v9, v9, v17
    v_mul_f32 v10, v10, v18
    v_mul_f32 v11, v11, v19
    v_mul_f32 v12, v12, v20
    v_mul_f32 v13, v13, v21
    v_mul_f32 v14, v14, v22
    v_mul_f32 v15, v15, v23
    v_cvt_pk_bf16_f32 v44, v8, v9
    v_cvt_pk_bf16_f32 v45, v10, v11
    v_cvt_pk_bf16_f32 v46, v12, v13
    v_cvt_pk_bf16_f32 v47, v14, v15
    s_waitcnt vmcnt(0)
    v_lshlrev_b32 v8, 16, v44
    v_and_b32 v9, 4294901760, v44
    v_lshlrev_b32 v16, 16, v40
    v_and_b32 v17, 4294901760, v40
    v_lshlrev_b32 v10, 16, v45
    v_and_b32 v11, 4294901760, v45
    v_lshlrev_b32 v18, 16, v41
    v_and_b32 v19, 4294901760, v41
    v_lshlrev_b32 v12, 16, v46
    v_and_b32 v13, 4294901760, v46
    v_lshlrev_b32 v20, 16, v42
    v_and_b32 v21, 4294901760, v42
    v_lshlrev_b32 v14, 16, v47
    v_and_b32 v15, 4294901760, v47
    v_lshlrev_b32 v22, 16, v43
    v_and_b32 v23, 4294901760, v43
    v_add_f32 v8, v8, v16
    v_add_f32 v9, v9, v17
    v_add_f32 v10, v10, v18
    v_add_f32 v11, v11, v19
    v_add_f32 v12, v12, v20
    v_add_f32 v13, v13, v21
    v_add_f32 v14, v14, v22
    v_add_f32 v15, v15, v23
    v_cvt_pk_bf16_f32 v44, v8, v9
    v_cvt_pk_bf16_f32 v45, v10, v11
    v_cvt_pk_bf16_f32 v46, v12, v13
    v_cvt_pk_bf16_f32 v47, v14, v15
    buffer_store_dwordx4 v[44:47], v6, s[12:15], s25 offen
L_fin_end:
    s_endpgm
.section .rodata,"a"
.p2align 6
.amdhsa_kernel ln_kernel
  .amdhsa_next_free_vgpr 48
  .amdhsa_next_free_sgpr 56
  .amdhsa_accum_offset 48
  .amdhsa_group_segment_fixed_size 0
  .amdhsa_kernarg_size 96
  .amdhsa_user_sgpr_count 2
  .amdhsa_user_sgpr_kernarg_segment_ptr 1
  .amdhsa_system_sgpr_workgroup_id_x 1
.end_amdhsa_kernel
.p2align 6
.amdhsa_kernel attn_kernel
  .amdhsa_next_free_vgpr 256
  .amdhsa_next_free_sgpr 100
  .amdhsa_accum_offset 256
  .amdhsa_group_segment_fixed_size 0
  .amdhsa_kernarg_size 96
  .amdhsa_user_sgpr_count 2
  .amdhsa_user_sgpr_kernarg_segment_ptr 1
  .amdhsa_system_sgpr_workgroup_id_x 1
.end_amdhsa_kernel
.p2align 6
.amdhsa_kernel gemm2_kernel
  .amdhsa_next_free_vgpr 192
  .amdhsa_next_free_sgpr 100
  .amdhsa_accum_offset 192
  .amdhsa_group_segment_fixed_size 0
  .amdhsa_kernarg_size 96
  .amdhsa_user_sgpr_count 2
  .amdhsa_user_sgpr_kernarg_segment_ptr 1
  .amdhsa_system_sgpr_workgroup_id_x 1
.end_amdhsa_kernel
.p2align 6
.amdhsa_kernel fin_kernel
  .amdhsa_next_free_vgpr 68
  .amdhsa_next_free_sgpr 44
  .amdhsa_accum_offset 68
  .amdhsa_group_segment_fixed_size 0
  .amdhsa_kernarg_size 96
  .amdhsa_user_sgpr_count 2
  .amdhsa_user_sgpr_kernarg_segment_ptr 1
  .amdhsa_system_sgpr_workgroup_id_x 1
.end_amdhsa_kernel
```
